```python
import torch

def _softmax(x, axis=-1):
    return torch.softmax(x, dim=axis)
def _gelu(x):
    return torch.nn.functional.gelu(x, approximate="tanh")
def _silu(x):
    return torch.nn.functional.silu(x)
def _sigmoid(x):
    return torch.sigmoid(x)
def _layernorm(x, axis=-1, eps=1e-5):
    m = x.mean(dim=axis, keepdim=True)
    v = x.var(dim=axis, keepdim=True, unbiased=False)
    return (x - m) / torch.sqrt(v + eps)
def _scatter_add(tgt, idx, src, axis=0):
    return tgt.clone().index_add_(axis, idx, src)
def _segment_sum(src, seg, n):
    out = torch.zeros((n,) + src.shape[1:], dtype=src.dtype)
    return out.index_add_(0, seg, src)
def _pad(x, pw):
    flat = tuple(v for pair in reversed(pw) for v in pair)
    return torch.nn.functional.pad(x, flat)

kernel_name = 'recurrent_scan__gqa_block_cached__glu_gated_geglu__decode'

def setup_inputs():

    _w = (lambda a: (lambda t: t.to(torch.bfloat16) if t.is_floating_point() else t)(torch.as_tensor(a)))
    def _A_setup():
        B, Sq, D = 1, 1, 576
        Hq, Hkv, Sk, Dh = 32, 16, 65536, 128
        assert Hq % Hkv == 0, (Hq, Hkv)
        return {
            "x": _w((lambda *s: torch.randn(*s, dtype=torch.bfloat16) * 0.4)(B, Sq, D)),
            "k_cache": _w((lambda *s: torch.randn(*s, dtype=torch.bfloat16) * 1.6)(B, Hkv, Sk, Dh)),
            "v_cache": _w((lambda *s: torch.randn(*s, dtype=torch.bfloat16) * 1.6)(B, Hkv, Sk, Dh)),
            "wq": _w((lambda *s: torch.randn(*s, dtype=torch.bfloat16) * 1.6)(D, Hq * Dh) * (D ** -0.5)),
            "wo": _w((lambda *s: torch.randn(*s, dtype=torch.bfloat16) * 1.6)(Hq * Dh, D) * ((Hq * Dh) ** -0.5)),
        }
    _A_in = _A_setup()

    def _B_setup():
        B, S, Dm, Df = 1, 1, 576, 4608
        return {
            "x": _w((lambda *s: torch.randn(*s, dtype=torch.bfloat16) * 0.4)(B, S, Dm)),
            "w_gate": _w((lambda *s: torch.randn(*s, dtype=torch.bfloat16) * 1.6)(Dm, Df) * (Dm ** -0.5)),
            "w_up": _w((lambda *s: torch.randn(*s, dtype=torch.bfloat16) * 1.6)(Dm, Df) * (Dm ** -0.5)),
            "w_down": _w((lambda *s: torch.randn(*s, dtype=torch.bfloat16) * 1.6)(Df, Dm) * (Df ** -0.5)),
        }
    _B_in = _B_setup()

    return {
        "A_x": _A_in["x"],
        "A_k_cache": _A_in["k_cache"],
        "A_v_cache": _A_in["v_cache"],
        "A_wq": _A_in["wq"],
        "A_wo": _A_in["wo"],
        "B_x": _B_in["x"],
        "B_w_gate": _B_in["w_gate"],
        "B_w_up": _B_in["w_up"],
        "B_w_down": _B_in["w_down"],
    }

def reference(A_x, A_k_cache, A_v_cache, A_wq, A_wo, B_x, B_w_gate, B_w_up, B_w_down):
    def _A_ref(x, k_cache, v_cache, wq, wo):
        B, Sq, D = x.shape
        Hq, Dh = 32, 128
        Hkv = k_cache.shape[1]
        rep = Hq // Hkv
        q = (lambda x, *d: x.permute(*d))((x @ wq).reshape(B, Sq, Hq, Dh), 0, 2, 1, 3)
        k = (lambda x, n, axis: torch.repeat_interleave(x, n, dim=axis))(k_cache, rep, axis=1)
        v = (lambda x, n, axis: torch.repeat_interleave(x, n, dim=axis))(v_cache, rep, axis=1)
        scores = torch.einsum("bhqd,bhkd->bhqk", q, k) * (Dh ** -0.5)
        p = _softmax(scores, axis=-1)
        o = torch.einsum("bhqk,bhkd->bhqd", p, v)
        return (lambda x, *d: x.permute(*d))(o, 0, 2, 1, 3).reshape(B, Sq, Hq * Dh) @ wo

    def _B_ref(x, w_gate, w_up, w_down):
        g = torch.einsum("bsd,df->bsf", x, w_gate)
        u = torch.einsum("bsd,df->bsf", x, w_up)
        h = _gelu(g) * u
        return torch.einsum("bsf,fd->bsd", h, w_down)

    x = A_x
    xn = _layernorm(x, axis=-1)
    s = _A_ref(xn, A_k_cache, A_v_cache, A_wq, A_wo)
    g = _silu(_B_ref(xn, B_w_gate, B_w_up, B_w_down))
    return x + s * g
```

```asm
; @launch kernel=k1_proj_kernel grid=(272,1,1) block=(256,1,1) lds=16384
; @launch kernel=k2_attn_kernel grid=(1024,1,1) block=(256,1,1) lds=16640
; @launch kernel=k3_out_kernel grid=(272,1,1) block=(320,1,1) lds=4096
; @launch kernel=k4_final_kernel grid=(9,1,1) block=(256,1,1) lds=2048
.amdgcn_target "amdgcn-amd-amdhsa--gfx950"
.text
.p2align 8
.globl k1_proj_kernel
.type k1_proj_kernel,@function
k1_proj_kernel:
    s_cmp_ge_u32 s2, 272
    s_cbranch_scc1 K1_exit
    s_load_dwordx16 s[16:31], s[0:1], 0
    s_load_dwordx8 s[32:39], s[0:1], 64
    v_and_b32 v1, 3, v0
    v_lshrrev_b32 v2, 2, v0
    v_and_b32 v3, 63, v0
    v_lshlrev_b32 v3, 2, v3
    s_waitcnt lgkmcnt(0)
    s_mov_b32 s40, s16
    s_and_b32 s41, s17, 0xffff
    s_mov_b32 s42, 1152
    s_mov_b32 s43, 0x00020000
    s_mov_b32 s56, s38
    s_and_b32 s57, s39, 0xffff
    s_mov_b32 s58, 1073741824
    s_mov_b32 s59, 0x00020000
    buffer_load_dword v4, v3, s[40:43], 0 offen offset:0
    buffer_load_dword v5, v3, s[40:43], 0 offen offset:256
    buffer_load_dword v6, v3, s[40:43], 0 offen offset:512
    buffer_load_dword v7, v3, s[40:43], 0 offen offset:768
    buffer_load_dword v8, v3, s[40:43], 0 offen offset:1024
    s_cmp_ge_u32 s2, 128
    s_cbranch_scc1 K1_gu_setup
    s_mov_b32 s48, s22
    s_and_b32 s49, s23, 0xffff
    s_mov_b32 s50, 4718592
    s_mov_b32 s51, 0x00020000
    s_lshl_b32 s46, s2, 6
    s_mov_b32 s47, 8192
    s_branch K1_issue
K1_gu_setup:
    s_mov_b32 s48, s28
    s_and_b32 s49, s29, 0xffff
    s_mov_b32 s50, 5308416
    s_mov_b32 s51, 0x00020000
    s_mov_b32 s52, s30
    s_and_b32 s53, s31, 0xffff
    s_mov_b32 s54, 5308416
    s_mov_b32 s55, 0x00020000
    s_sub_u32 s46, s2, 128
    s_lshl_b32 s46, s46, 6
    s_mov_b32 s47, 9216
K1_issue:
    v_mul_lo_u32 v13, v2, s47
    v_lshlrev_b32 v14, 4, v1
    v_add_u32 v13, v13, v14
    s_lshl_b32 s60, s47, 6
    s_mov_b32 s47, s46
    buffer_load_dwordx4 v[16:19], v13, s[48:51], s47 offen
    s_add_u32 s47, s47, s60
    buffer_load_dwordx4 v[20:23], v13, s[48:51], s47 offen
    s_add_u32 s47, s47, s60
    buffer_load_dwordx4 v[24:27], v13, s[48:51], s47 offen
    s_add_u32 s47, s47, s60
    buffer_load_dwordx4 v[28:31], v13, s[48:51], s47 offen
    s_add_u32 s47, s47, s60
    buffer_load_dwordx4 v[32:35], v13, s[48:51], s47 offen
    s_add_u32 s47, s47, s60
    buffer_load_dwordx4 v[36:39], v13, s[48:51], s47 offen
    s_add_u32 s47, s47, s60
    buffer_load_dwordx4 v[40:43], v13, s[48:51], s47 offen
    s_add_u32 s47, s47, s60
    buffer_load_dwordx4 v[44:47], v13, s[48:51], s47 offen
    s_add_u32 s47, s47, s60
    buffer_load_dwordx4 v[48:51], v13, s[48:51], s47 offen
    s_cmp_ge_u32 s2, 128
    s_cbranch_scc0 K1_ln
    s_mov_b32 s47, s46
    buffer_load_dwordx4 v[52:55], v13, s[52:55], s47 offen
    s_add_u32 s47, s47, s60
    buffer_load_dwordx4 v[56:59], v13, s[52:55], s47 offen
    s_add_u32 s47, s47, s60
    buffer_load_dwordx4 v[60:63], v13, s[52:55], s47 offen
    s_add_u32 s47, s47, s60
    buffer_load_dwordx4 v[64:67], v13, s[52:55], s47 offen
    s_add_u32 s47, s47, s60
    buffer_load_dwordx4 v[68:71], v13, s[52:55], s47 offen
    s_add_u32 s47, s47, s60
    buffer_load_dwordx4 v[72:75], v13, s[52:55], s47 offen
    s_add_u32 s47, s47, s60
    buffer_load_dwordx4 v[76:79], v13, s[52:55], s47 offen
    s_add_u32 s47, s47, s60
    buffer_load_dwordx4 v[80:83], v13, s[52:55], s47 offen
    s_add_u32 s47, s47, s60
    buffer_load_dwordx4 v[84:87], v13, s[52:55], s47 offen
    s_waitcnt vmcnt(18)
    s_branch K1_ln2
K1_ln:
    s_waitcnt vmcnt(9)
K1_ln2:
    v_lshlrev_b32 v90, 16, v4
    v_and_b32 v91, 0xffff0000, v4
    v_lshlrev_b32 v92, 16, v5
    v_and_b32 v93, 0xffff0000, v5
    v_lshlrev_b32 v94, 16, v6
    v_and_b32 v95, 0xffff0000, v6
    v_lshlrev_b32 v96, 16, v7
    v_and_b32 v97, 0xffff0000, v7
    v_lshlrev_b32 v98, 16, v8
    v_and_b32 v99, 0xffff0000, v8
    v_cmp_gt_u32 vcc, 32, v0
    v_and_b32 v9, 63, v0
    v_cmp_gt_u32 vcc, 32, v9
    s_mov_b64 s[44:45], vcc
    v_add_f32 v10, v90, v91
    v_add_f32 v10, v10, v92
    v_add_f32 v10, v10, v93
    v_add_f32 v10, v10, v94
    v_add_f32 v10, v10, v95
    v_add_f32 v10, v10, v96
    v_add_f32 v10, v10, v97
    v_add_f32 v10, v10, v98
    v_add_f32 v10, v10, v99
    s_nop 1
    v_add_f32_dpp v10, v10, v10 row_ror:8 row_mask:0xf bank_mask:0xf
    s_nop 1
    v_add_f32_dpp v10, v10, v10 row_ror:4 row_mask:0xf bank_mask:0xf
    s_nop 1
    v_add_f32_dpp v10, v10, v10 row_ror:2 row_mask:0xf bank_mask:0xf
    s_nop 1
    v_add_f32_dpp v10, v10, v10 row_ror:1 row_mask:0xf bank_mask:0xf
    s_nop 1
    s_nop 1
    v_readlane_b32 s62, v10, 0
    v_readlane_b32 s63, v10, 16
    v_readlane_b32 s64, v10, 32
    v_readlane_b32 s65, v10, 48
    s_nop 2
    v_mov_b32 v10, s62
    v_add_f32 v10, s63, v10
    v_add_f32 v10, s64, v10
    v_add_f32 v10, s65, v10
    v_mul_f32 v100, 0x3ae38e39, v10
    v_mov_b32 v10, 0
    v_sub_f32 v11, v90, v100
    v_fmac_f32 v10, v11, v11
    v_sub_f32 v11, v91, v100
    v_fmac_f32 v10, v11, v11
    v_sub_f32 v11, v92, v100
    v_fmac_f32 v10, v11, v11
    v_sub_f32 v11, v93, v100
    v_fmac_f32 v10, v11, v11
    v_sub_f32 v11, v94, v100
    v_fmac_f32 v10, v11, v11
    v_sub_f32 v11, v95, v100
    v_fmac_f32 v10, v11, v11
    v_sub_f32 v11, v96, v100
    v_fmac_f32 v10, v11, v11
    v_sub_f32 v11, v97, v100
    v_fmac_f32 v10, v11, v11
    v_sub_f32 v11, v98, v100
    v_sub_f32 v12, v99, v100
    v_mul_f32 v11, v11, v11
    v_fmac_f32 v11, v12, v12
    v_cndmask_b32 v11, 0, v11, s[44:45]
    v_add_f32 v10, v10, v11
    s_nop 1
    v_add_f32_dpp v10, v10, v10 row_ror:8 row_mask:0xf bank_mask:0xf
    s_nop 1
    v_add_f32_dpp v10, v10, v10 row_ror:4 row_mask:0xf bank_mask:0xf
    s_nop 1
    v_add_f32_dpp v10, v10, v10 row_ror:2 row_mask:0xf bank_mask:0xf
    s_nop 1
    v_add_f32_dpp v10, v10, v10 row_ror:1 row_mask:0xf bank_mask:0xf
    s_nop 1
    s_nop 1
    v_readlane_b32 s62, v10, 0
    v_readlane_b32 s63, v10, 16
    v_readlane_b32 s64, v10, 32
    v_readlane_b32 s65, v10, 48
    s_nop 2
    v_mov_b32 v10, s62
    v_add_f32 v10, s63, v10
    v_add_f32 v10, s64, v10
    v_add_f32 v10, s65, v10
    v_mul_f32 v101, 0x3ae38e39, v10
    v_cvt_pk_bf16_f32 v100, v100, v100
    v_and_b32 v100, 0xffff0000, v100
    v_cvt_pk_bf16_f32 v101, v101, v101
    v_and_b32 v101, 0xffff0000, v101
    v_add_f32 v101, 0x3727c5ac, v101
    v_cvt_pk_bf16_f32 v101, v101, v101
    v_and_b32 v101, 0xffff0000, v101
    v_sqrt_f32 v101, v101
    s_nop 1
    v_cvt_pk_bf16_f32 v101, v101, v101
    v_and_b32 v101, 0xffff0000, v101
    v_rcp_f32 v102, v101
    s_nop 1
    v_sub_f32 v90, v90, v100
    v_cvt_pk_bf16_f32 v90, v90, v90
    v_and_b32 v90, 0xffff0000, v90
    v_mul_f32 v10, v90, v102
    v_fma_f32 v11, -v101, v10, v90
    v_fma_f32 v90, v11, v102, v10
    v_cvt_pk_bf16_f32 v90, v90, v90
    v_and_b32 v90, 0xffff0000, v90
    v_sub_f32 v91, v91, v100
    v_cvt_pk_bf16_f32 v91, v91, v91
    v_and_b32 v91, 0xffff0000, v91
    v_mul_f32 v10, v91, v102
    v_fma_f32 v11, -v101, v10, v91
    v_fma_f32 v91, v11, v102, v10
    v_cvt_pk_bf16_f32 v91, v91, v91
    v_and_b32 v91, 0xffff0000, v91
    v_sub_f32 v92, v92, v100
    v_cvt_pk_bf16_f32 v92, v92, v92
    v_and_b32 v92, 0xffff0000, v92
    v_mul_f32 v10, v92, v102
    v_fma_f32 v11, -v101, v10, v92
    v_fma_f32 v92, v11, v102, v10
    v_cvt_pk_bf16_f32 v92, v92, v92
    v_and_b32 v92, 0xffff0000, v92
    v_sub_f32 v93, v93, v100
    v_cvt_pk_bf16_f32 v93, v93, v93
    v_and_b32 v93, 0xffff0000, v93
    v_mul_f32 v10, v93, v102
    v_fma_f32 v11, -v101, v10, v93
    v_fma_f32 v93, v11, v102, v10
    v_cvt_pk_bf16_f32 v93, v93, v93
    v_and_b32 v93, 0xffff0000, v93
    v_sub_f32 v94, v94, v100
    v_cvt_pk_bf16_f32 v94, v94, v94
    v_and_b32 v94, 0xffff0000, v94
    v_mul_f32 v10, v94, v102
    v_fma_f32 v11, -v101, v10, v94
    v_fma_f32 v94, v11, v102, v10
    v_cvt_pk_bf16_f32 v94, v94, v94
    v_and_b32 v94, 0xffff0000, v94
    v_sub_f32 v95, v95, v100
    v_cvt_pk_bf16_f32 v95, v95, v95
    v_and_b32 v95, 0xffff0000, v95
    v_mul_f32 v10, v95, v102
    v_fma_f32 v11, -v101, v10, v95
    v_fma_f32 v95, v11, v102, v10
    v_cvt_pk_bf16_f32 v95, v95, v95
    v_and_b32 v95, 0xffff0000, v95
    v_sub_f32 v96, v96, v100
    v_cvt_pk_bf16_f32 v96, v96, v96
    v_and_b32 v96, 0xffff0000, v96
    v_mul_f32 v10, v96, v102
    v_fma_f32 v11, -v101, v10, v96
    v_fma_f32 v96, v11, v102, v10
    v_cvt_pk_bf16_f32 v96, v96, v96
    v_and_b32 v96, 0xffff0000, v96
    v_sub_f32 v97, v97, v100
    v_cvt_pk_bf16_f32 v97, v97, v97
    v_and_b32 v97, 0xffff0000, v97
    v_mul_f32 v10, v97, v102
    v_fma_f32 v11, -v101, v10, v97
    v_fma_f32 v97, v11, v102, v10
    v_cvt_pk_bf16_f32 v97, v97, v97
    v_and_b32 v97, 0xffff0000, v97
    v_sub_f32 v98, v98, v100
    v_cvt_pk_bf16_f32 v98, v98, v98
    v_and_b32 v98, 0xffff0000, v98
    v_mul_f32 v10, v98, v102
    v_fma_f32 v11, -v101, v10, v98
    v_fma_f32 v98, v11, v102, v10
    v_cvt_pk_bf16_f32 v98, v98, v98
    v_and_b32 v98, 0xffff0000, v98
    v_sub_f32 v99, v99, v100
    v_cvt_pk_bf16_f32 v99, v99, v99
    v_and_b32 v99, 0xffff0000, v99
    v_mul_f32 v10, v99, v102
    v_fma_f32 v11, -v101, v10, v99
    v_fma_f32 v99, v11, v102, v10
    v_cvt_pk_bf16_f32 v99, v99, v99
    v_and_b32 v99, 0xffff0000, v99
    v_lshrrev_b32 v9, 6, v0
    v_mul_u32_u24 v9, 2560, v9
    v_lshlrev_b32 v10, 1, v3
    v_add_u32 v10, v10, v9
    ds_write_b64 v10, v[90:91] offset:0
    ds_write_b64 v10, v[92:93] offset:512
    ds_write_b64 v10, v[94:95] offset:1024
    ds_write_b64 v10, v[96:97] offset:1536
    ds_write_b64 v10, v[98:99] offset:2048
    v_lshlrev_b32 v14, 2, v2
    v_add_u32 v14, v14, v9
    s_waitcnt lgkmcnt(0)
    ds_read_b32 v4, v14 offset:0
    ds_read_b32 v5, v14 offset:256
    ds_read_b32 v6, v14 offset:512
    ds_read_b32 v7, v14 offset:768
    ds_read_b32 v8, v14 offset:1024
    ds_read_b32 v9, v14 offset:1280
    ds_read_b32 v10, v14 offset:1536
    ds_read_b32 v11, v14 offset:1792
    ds_read_b32 v12, v14 offset:2048
    s_cmp_ge_u32 s2, 128
    s_cbranch_scc1 K1_gateup
    v_mov_b32 v52, 0
    v_mov_b32 v53, 0
    v_mov_b32 v54, 0
    v_mov_b32 v55, 0
    v_mov_b32 v56, 0
    v_mov_b32 v57, 0
    v_mov_b32 v58, 0
    v_mov_b32 v59, 0
    s_waitcnt lgkmcnt(0)
    s_waitcnt vmcnt(8)
    v_lshlrev_b32 v14, 16, v16
    v_and_b32 v15, 0xffff0000, v16
    v_fmac_f32 v52, v14, v4
    v_fmac_f32 v53, v15, v4
    v_lshlrev_b32 v14, 16, v17
    v_and_b32 v15, 0xffff0000, v17
    v_fmac_f32 v54, v14, v4
    v_fmac_f32 v55, v15, v4
    v_lshlrev_b32 v14, 16, v18
    v_and_b32 v15, 0xffff0000, v18
    v_fmac_f32 v56, v14, v4
    v_fmac_f32 v57, v15, v4
    v_lshlrev_b32 v14, 16, v19
    v_and_b32 v15, 0xffff0000, v19
    v_fmac_f32 v58, v14, v4
    v_fmac_f32 v59, v15, v4
    s_waitcnt vmcnt(7)
    v_lshlrev_b32 v14, 16, v20
    v_and_b32 v15, 0xffff0000, v20
    v_fmac_f32 v52, v14, v5
    v_fmac_f32 v53, v15, v5
    v_lshlrev_b32 v14, 16, v21
    v_and_b32 v15, 0xffff0000, v21
    v_fmac_f32 v54, v14, v5
    v_fmac_f32 v55, v15, v5
    v_lshlrev_b32 v14, 16, v22
    v_and_b32 v15, 0xffff0000, v22
    v_fmac_f32 v56, v14, v5
    v_fmac_f32 v57, v15, v5
    v_lshlrev_b32 v14, 16, v23
    v_and_b32 v15, 0xffff0000, v23
    v_fmac_f32 v58, v14, v5
    v_fmac_f32 v59, v15, v5
    s_waitcnt vmcnt(6)
    v_lshlrev_b32 v14, 16, v24
    v_and_b32 v15, 0xffff0000, v24
    v_fmac_f32 v52, v14, v6
    v_fmac_f32 v53, v15, v6
    v_lshlrev_b32 v14, 16, v25
    v_and_b32 v15, 0xffff0000, v25
    v_fmac_f32 v54, v14, v6
    v_fmac_f32 v55, v15, v6
    v_lshlrev_b32 v14, 16, v26
    v_and_b32 v15, 0xffff0000, v26
    v_fmac_f32 v56, v14, v6
    v_fmac_f32 v57, v15, v6
    v_lshlrev_b32 v14, 16, v27
    v_and_b32 v15, 0xffff0000, v27
    v_fmac_f32 v58, v14, v6
    v_fmac_f32 v59, v15, v6
    s_waitcnt vmcnt(5)
    v_lshlrev_b32 v14, 16, v28
    v_and_b32 v15, 0xffff0000, v28
    v_fmac_f32 v52, v14, v7
    v_fmac_f32 v53, v15, v7
    v_lshlrev_b32 v14, 16, v29
    v_and_b32 v15, 0xffff0000, v29
    v_fmac_f32 v54, v14, v7
    v_fmac_f32 v55, v15, v7
    v_lshlrev_b32 v14, 16, v30
    v_and_b32 v15, 0xffff0000, v30
    v_fmac_f32 v56, v14, v7
    v_fmac_f32 v57, v15, v7
    v_lshlrev_b32 v14, 16, v31
    v_and_b32 v15, 0xffff0000, v31
    v_fmac_f32 v58, v14, v7
    v_fmac_f32 v59, v15, v7
    s_waitcnt vmcnt(4)
    v_lshlrev_b32 v14, 16, v32
    v_and_b32 v15, 0xffff0000, v32
    v_fmac_f32 v52, v14, v8
    v_fmac_f32 v53, v15, v8
    v_lshlrev_b32 v14, 16, v33
    v_and_b32 v15, 0xffff0000, v33
    v_fmac_f32 v54, v14, v8
    v_fmac_f32 v55, v15, v8
    v_lshlrev_b32 v14, 16, v34
    v_and_b32 v15, 0xffff0000, v34
    v_fmac_f32 v56, v14, v8
    v_fmac_f32 v57, v15, v8
    v_lshlrev_b32 v14, 16, v35
    v_and_b32 v15, 0xffff0000, v35
    v_fmac_f32 v58, v14, v8
    v_fmac_f32 v59, v15, v8
    s_waitcnt vmcnt(3)
    v_lshlrev_b32 v14, 16, v36
    v_and_b32 v15, 0xffff0000, v36
    v_fmac_f32 v52, v14, v9
    v_fmac_f32 v53, v15, v9
    v_lshlrev_b32 v14, 16, v37
    v_and_b32 v15, 0xffff0000, v37
    v_fmac_f32 v54, v14, v9
    v_fmac_f32 v55, v15, v9
    v_lshlrev_b32 v14, 16, v38
    v_and_b32 v15, 0xffff0000, v38
    v_fmac_f32 v56, v14, v9
    v_fmac_f32 v57, v15, v9
    v_lshlrev_b32 v14, 16, v39
    v_and_b32 v15, 0xffff0000, v39
    v_fmac_f32 v58, v14, v9
    v_fmac_f32 v59, v15, v9
    s_waitcnt vmcnt(2)
    v_lshlrev_b32 v14, 16, v40
    v_and_b32 v15, 0xffff0000, v40
    v_fmac_f32 v52, v14, v10
    v_fmac_f32 v53, v15, v10
    v_lshlrev_b32 v14, 16, v41
    v_and_b32 v15, 0xffff0000, v41
    v_fmac_f32 v54, v14, v10
    v_fmac_f32 v55, v15, v10
    v_lshlrev_b32 v14, 16, v42
    v_and_b32 v15, 0xffff0000, v42
    v_fmac_f32 v56, v14, v10
    v_fmac_f32 v57, v15, v10
    v_lshlrev_b32 v14, 16, v43
    v_and_b32 v15, 0xffff0000, v43
    v_fmac_f32 v58, v14, v10
    v_fmac_f32 v59, v15, v10
    s_waitcnt vmcnt(1)
    v_lshlrev_b32 v14, 16, v44
    v_and_b32 v15, 0xffff0000, v44
    v_fmac_f32 v52, v14, v11
    v_fmac_f32 v53, v15, v11
    v_lshlrev_b32 v14, 16, v45
    v_and_b32 v15, 0xffff0000, v45
    v_fmac_f32 v54, v14, v11
    v_fmac_f32 v55, v15, v11
    v_lshlrev_b32 v14, 16, v46
    v_and_b32 v15, 0xffff0000, v46
    v_fmac_f32 v56, v14, v11
    v_fmac_f32 v57, v15, v11
    v_lshlrev_b32 v14, 16, v47
    v_and_b32 v15, 0xffff0000, v47
    v_fmac_f32 v58, v14, v11
    v_fmac_f32 v59, v15, v11
    s_waitcnt vmcnt(0)
    v_lshlrev_b32 v14, 16, v48
    v_and_b32 v15, 0xffff0000, v48
    v_fmac_f32 v52, v14, v12
    v_fmac_f32 v53, v15, v12
    v_lshlrev_b32 v14, 16, v49
    v_and_b32 v15, 0xffff0000, v49
    v_fmac_f32 v54, v14, v12
    v_fmac_f32 v55, v15, v12
    v_lshlrev_b32 v14, 16, v50
    v_and_b32 v15, 0xffff0000, v50
    v_fmac_f32 v56, v14, v12
    v_fmac_f32 v57, v15, v12
    v_lshlrev_b32 v14, 16, v51
    v_and_b32 v15, 0xffff0000, v51
    v_fmac_f32 v58, v14, v12
    v_fmac_f32 v59, v15, v12
    v_add_f32_dpp v52, v52, v52 row_ror:4 row_mask:0xf bank_mask:0xf
    v_add_f32_dpp v53, v53, v53 row_ror:4 row_mask:0xf bank_mask:0xf
    v_add_f32_dpp v54, v54, v54 row_ror:4 row_mask:0xf bank_mask:0xf
    v_add_f32_dpp v55, v55, v55 row_ror:4 row_mask:0xf bank_mask:0xf
    v_add_f32_dpp v56, v56, v56 row_ror:4 row_mask:0xf bank_mask:0xf
    v_add_f32_dpp v57, v57, v57 row_ror:4 row_mask:0xf bank_mask:0xf
    v_add_f32_dpp v58, v58, v58 row_ror:4 row_mask:0xf bank_mask:0xf
    v_add_f32_dpp v59, v59, v59 row_ror:4 row_mask:0xf bank_mask:0xf
    v_add_f32_dpp v52, v52, v52 row_ror:8 row_mask:0xf bank_mask:0xf
    v_add_f32_dpp v53, v53, v53 row_ror:8 row_mask:0xf bank_mask:0xf
    v_add_f32_dpp v54, v54, v54 row_ror:8 row_mask:0xf bank_mask:0xf
    v_add_f32_dpp v55, v55, v55 row_ror:8 row_mask:0xf bank_mask:0xf
    v_add_f32_dpp v56, v56, v56 row_ror:8 row_mask:0xf bank_mask:0xf
    v_add_f32_dpp v57, v57, v57 row_ror:8 row_mask:0xf bank_mask:0xf
    v_add_f32_dpp v58, v58, v58 row_ror:8 row_mask:0xf bank_mask:0xf
    v_add_f32_dpp v59, v59, v59 row_ror:8 row_mask:0xf bank_mask:0xf
    v_lshrrev_b32 v14, 4, v0
    v_lshlrev_b32 v14, 7, v14
    v_lshlrev_b32 v15, 5, v1
    v_add_u32 v14, v14, v15
    ds_write_b128 v14, v[52:55] offset:12288
    ds_write_b128 v14, v[56:59] offset:12304
    s_waitcnt lgkmcnt(0)
    s_barrier
    v_and_b32 v14, 31, v0
    v_lshlrev_b32 v14, 2, v14
    ds_read_b32 v20, v14 offset:12288
    ds_read_b32 v21, v14 offset:12416
    ds_read_b32 v22, v14 offset:12544
    ds_read_b32 v23, v14 offset:12672
    ds_read_b32 v24, v14 offset:12800
    ds_read_b32 v25, v14 offset:12928
    ds_read_b32 v26, v14 offset:13056
    ds_read_b32 v27, v14 offset:13184
    ds_read_b32 v28, v14 offset:13312
    ds_read_b32 v29, v14 offset:13440
    ds_read_b32 v30, v14 offset:13568
    ds_read_b32 v31, v14 offset:13696
    ds_read_b32 v32, v14 offset:13824
    ds_read_b32 v33, v14 offset:13952
    ds_read_b32 v34, v14 offset:14080
    ds_read_b32 v35, v14 offset:14208
    s_waitcnt lgkmcnt(0)
    v_add_f32 v20, v20, v21
    v_add_f32 v22, v22, v23
    v_add_f32 v24, v24, v25
    v_add_f32 v26, v26, v27
    v_add_f32 v28, v28, v29
    v_add_f32 v30, v30, v31
    v_add_f32 v32, v32, v33
    v_add_f32 v34, v34, v35
    v_add_f32 v20, v20, v22
    v_add_f32 v24, v24, v26
    v_add_f32 v28, v28, v30
    v_add_f32 v32, v32, v34
    v_add_f32 v20, v20, v24
    v_add_f32 v28, v28, v32
    v_add_f32 v20, v20, v28
    v_cvt_pk_bf16_f32 v20, v20, v20
    v_and_b32 v20, 0xffff0000, v20
    v_lshrrev_b32 v21, 16, v20
    v_lshlrev_b32 v22, 1, v0
    v_add_u32 v22, s46, v22
    v_cmp_gt_u32 vcc, 32, v0
    s_and_saveexec_b64 s[44:45], vcc
    s_cbranch_execz K1_exit
    buffer_store_short v21, v22, s[56:59], 0 offen offset:0
    s_branch K1_exit
K1_gateup:
    v_mov_b32 v88, 0
    v_mov_b32 v89, 0
    v_mov_b32 v90, 0
    v_mov_b32 v91, 0
    v_mov_b32 v92, 0
    v_mov_b32 v93, 0
    v_mov_b32 v94, 0
    v_mov_b32 v95, 0
    v_mov_b32 v96, 0
    v_mov_b32 v97, 0
    v_mov_b32 v98, 0
    v_mov_b32 v99, 0
    v_mov_b32 v100, 0
    v_mov_b32 v101, 0
    v_mov_b32 v102, 0
    v_mov_b32 v103, 0
    s_waitcnt lgkmcnt(0)
    s_waitcnt vmcnt(17)
    v_lshlrev_b32 v14, 16, v16
    v_and_b32 v15, 0xffff0000, v16
    v_fmac_f32 v88, v14, v4
    v_fmac_f32 v89, v15, v4
    v_lshlrev_b32 v14, 16, v17
    v_and_b32 v15, 0xffff0000, v17
    v_fmac_f32 v90, v14, v4
    v_fmac_f32 v91, v15, v4
    v_lshlrev_b32 v14, 16, v18
    v_and_b32 v15, 0xffff0000, v18
    v_fmac_f32 v92, v14, v4
    v_fmac_f32 v93, v15, v4
    v_lshlrev_b32 v14, 16, v19
    v_and_b32 v15, 0xffff0000, v19
    v_fmac_f32 v94, v14, v4
    v_fmac_f32 v95, v15, v4
    s_waitcnt vmcnt(16)
    v_lshlrev_b32 v14, 16, v20
    v_and_b32 v15, 0xffff0000, v20
    v_fmac_f32 v88, v14, v5
    v_fmac_f32 v89, v15, v5
    v_lshlrev_b32 v14, 16, v21
    v_and_b32 v15, 0xffff0000, v21
    v_fmac_f32 v90, v14, v5
    v_fmac_f32 v91, v15, v5
    v_lshlrev_b32 v14, 16, v22
    v_and_b32 v15, 0xffff0000, v22
    v_fmac_f32 v92, v14, v5
    v_fmac_f32 v93, v15, v5
    v_lshlrev_b32 v14, 16, v23
    v_and_b32 v15, 0xffff0000, v23
    v_fmac_f32 v94, v14, v5
    v_fmac_f32 v95, v15, v5
    s_waitcnt vmcnt(15)
    v_lshlrev_b32 v14, 16, v24
    v_and_b32 v15, 0xffff0000, v24
    v_fmac_f32 v88, v14, v6
    v_fmac_f32 v89, v15, v6
    v_lshlrev_b32 v14, 16, v25
    v_and_b32 v15, 0xffff0000, v25
    v_fmac_f32 v90, v14, v6
    v_fmac_f32 v91, v15, v6
    v_lshlrev_b32 v14, 16, v26
    v_and_b32 v15, 0xffff0000, v26
    v_fmac_f32 v92, v14, v6
    v_fmac_f32 v93, v15, v6
    v_lshlrev_b32 v14, 16, v27
    v_and_b32 v15, 0xffff0000, v27
    v_fmac_f32 v94, v14, v6
    v_fmac_f32 v95, v15, v6
    s_waitcnt vmcnt(14)
    v_lshlrev_b32 v14, 16, v28
    v_and_b32 v15, 0xffff0000, v28
    v_fmac_f32 v88, v14, v7
    v_fmac_f32 v89, v15, v7
    v_lshlrev_b32 v14, 16, v29
    v_and_b32 v15, 0xffff0000, v29
    v_fmac_f32 v90, v14, v7
    v_fmac_f32 v91, v15, v7
    v_lshlrev_b32 v14, 16, v30
    v_and_b32 v15, 0xffff0000, v30
    v_fmac_f32 v92, v14, v7
    v_fmac_f32 v93, v15, v7
    v_lshlrev_b32 v14, 16, v31
    v_and_b32 v15, 0xffff0000, v31
    v_fmac_f32 v94, v14, v7
    v_fmac_f32 v95, v15, v7
    s_waitcnt vmcnt(13)
    v_lshlrev_b32 v14, 16, v32
    v_and_b32 v15, 0xffff0000, v32
    v_fmac_f32 v88, v14, v8
    v_fmac_f32 v89, v15, v8
    v_lshlrev_b32 v14, 16, v33
    v_and_b32 v15, 0xffff0000, v33
    v_fmac_f32 v90, v14, v8
    v_fmac_f32 v91, v15, v8
    v_lshlrev_b32 v14, 16, v34
    v_and_b32 v15, 0xffff0000, v34
    v_fmac_f32 v92, v14, v8
    v_fmac_f32 v93, v15, v8
    v_lshlrev_b32 v14, 16, v35
    v_and_b32 v15, 0xffff0000, v35
    v_fmac_f32 v94, v14, v8
    v_fmac_f32 v95, v15, v8
    s_waitcnt vmcnt(12)
    v_lshlrev_b32 v14, 16, v36
    v_and_b32 v15, 0xffff0000, v36
    v_fmac_f32 v88, v14, v9
    v_fmac_f32 v89, v15, v9
    v_lshlrev_b32 v14, 16, v37
    v_and_b32 v15, 0xffff0000, v37
    v_fmac_f32 v90, v14, v9
    v_fmac_f32 v91, v15, v9
    v_lshlrev_b32 v14, 16, v38
    v_and_b32 v15, 0xffff0000, v38
    v_fmac_f32 v92, v14, v9
    v_fmac_f32 v93, v15, v9
    v_lshlrev_b32 v14, 16, v39
    v_and_b32 v15, 0xffff0000, v39
    v_fmac_f32 v94, v14, v9
    v_fmac_f32 v95, v15, v9
    s_waitcnt vmcnt(11)
    v_lshlrev_b32 v14, 16, v40
    v_and_b32 v15, 0xffff0000, v40
    v_fmac_f32 v88, v14, v10
    v_fmac_f32 v89, v15, v10
    v_lshlrev_b32 v14, 16, v41
    v_and_b32 v15, 0xffff0000, v41
    v_fmac_f32 v90, v14, v10
    v_fmac_f32 v91, v15, v10
    v_lshlrev_b32 v14, 16, v42
    v_and_b32 v15, 0xffff0000, v42
    v_fmac_f32 v92, v14, v10
    v_fmac_f32 v93, v15, v10
    v_lshlrev_b32 v14, 16, v43
    v_and_b32 v15, 0xffff0000, v43
    v_fmac_f32 v94, v14, v10
    v_fmac_f32 v95, v15, v10
    s_waitcnt vmcnt(10)
    v_lshlrev_b32 v14, 16, v44
    v_and_b32 v15, 0xffff0000, v44
    v_fmac_f32 v88, v14, v11
    v_fmac_f32 v89, v15, v11
    v_lshlrev_b32 v14, 16, v45
    v_and_b32 v15, 0xffff0000, v45
    v_fmac_f32 v90, v14, v11
    v_fmac_f32 v91, v15, v11
    v_lshlrev_b32 v14, 16, v46
    v_and_b32 v15, 0xffff0000, v46
    v_fmac_f32 v92, v14, v11
    v_fmac_f32 v93, v15, v11
    v_lshlrev_b32 v14, 16, v47
    v_and_b32 v15, 0xffff0000, v47
    v_fmac_f32 v94, v14, v11
    v_fmac_f32 v95, v15, v11
    s_waitcnt vmcnt(9)
    v_lshlrev_b32 v14, 16, v48
    v_and_b32 v15, 0xffff0000, v48
    v_fmac_f32 v88, v14, v12
    v_fmac_f32 v89, v15, v12
    v_lshlrev_b32 v14, 16, v49
    v_and_b32 v15, 0xffff0000, v49
    v_fmac_f32 v90, v14, v12
    v_fmac_f32 v91, v15, v12
    v_lshlrev_b32 v14, 16, v50
    v_and_b32 v15, 0xffff0000, v50
    v_fmac_f32 v92, v14, v12
    v_fmac_f32 v93, v15, v12
    v_lshlrev_b32 v14, 16, v51
    v_and_b32 v15, 0xffff0000, v51
    v_fmac_f32 v94, v14, v12
    v_fmac_f32 v95, v15, v12
    s_waitcnt vmcnt(8)
    v_lshlrev_b32 v14, 16, v52
    v_and_b32 v15, 0xffff0000, v52
    v_fmac_f32 v96, v14, v4
    v_fmac_f32 v97, v15, v4
    v_lshlrev_b32 v14, 16, v53
    v_and_b32 v15, 0xffff0000, v53
    v_fmac_f32 v98, v14, v4
    v_fmac_f32 v99, v15, v4
    v_lshlrev_b32 v14, 16, v54
    v_and_b32 v15, 0xffff0000, v54
    v_fmac_f32 v100, v14, v4
    v_fmac_f32 v101, v15, v4
    v_lshlrev_b32 v14, 16, v55
    v_and_b32 v15, 0xffff0000, v55
    v_fmac_f32 v102, v14, v4
    v_fmac_f32 v103, v15, v4
    s_waitcnt vmcnt(7)
    v_lshlrev_b32 v14, 16, v56
    v_and_b32 v15, 0xffff0000, v56
    v_fmac_f32 v96, v14, v5
    v_fmac_f32 v97, v15, v5
    v_lshlrev_b32 v14, 16, v57
    v_and_b32 v15, 0xffff0000, v57
    v_fmac_f32 v98, v14, v5
    v_fmac_f32 v99, v15, v5
    v_lshlrev_b32 v14, 16, v58
    v_and_b32 v15, 0xffff0000, v58
    v_fmac_f32 v100, v14, v5
    v_fmac_f32 v101, v15, v5
    v_lshlrev_b32 v14, 16, v59
    v_and_b32 v15, 0xffff0000, v59
    v_fmac_f32 v102, v14, v5
    v_fmac_f32 v103, v15, v5
    s_waitcnt vmcnt(6)
    v_lshlrev_b32 v14, 16, v60
    v_and_b32 v15, 0xffff0000, v60
    v_fmac_f32 v96, v14, v6
    v_fmac_f32 v97, v15, v6
    v_lshlrev_b32 v14, 16, v61
    v_and_b32 v15, 0xffff0000, v61
    v_fmac_f32 v98, v14, v6
    v_fmac_f32 v99, v15, v6
    v_lshlrev_b32 v14, 16, v62
    v_and_b32 v15, 0xffff0000, v62
    v_fmac_f32 v100, v14, v6
    v_fmac_f32 v101, v15, v6
    v_lshlrev_b32 v14, 16, v63
    v_and_b32 v15, 0xffff0000, v63
    v_fmac_f32 v102, v14, v6
    v_fmac_f32 v103, v15, v6
    s_waitcnt vmcnt(5)
    v_lshlrev_b32 v14, 16, v64
    v_and_b32 v15, 0xffff0000, v64
    v_fmac_f32 v96, v14, v7
    v_fmac_f32 v97, v15, v7
    v_lshlrev_b32 v14, 16, v65
    v_and_b32 v15, 0xffff0000, v65
    v_fmac_f32 v98, v14, v7
    v_fmac_f32 v99, v15, v7
    v_lshlrev_b32 v14, 16, v66
    v_and_b32 v15, 0xffff0000, v66
    v_fmac_f32 v100, v14, v7
    v_fmac_f32 v101, v15, v7
    v_lshlrev_b32 v14, 16, v67
    v_and_b32 v15, 0xffff0000, v67
    v_fmac_f32 v102, v14, v7
    v_fmac_f32 v103, v15, v7
    s_waitcnt vmcnt(4)
    v_lshlrev_b32 v14, 16, v68
    v_and_b32 v15, 0xffff0000, v68
    v_fmac_f32 v96, v14, v8
    v_fmac_f32 v97, v15, v8
    v_lshlrev_b32 v14, 16, v69
    v_and_b32 v15, 0xffff0000, v69
    v_fmac_f32 v98, v14, v8
    v_fmac_f32 v99, v15, v8
    v_lshlrev_b32 v14, 16, v70
    v_and_b32 v15, 0xffff0000, v70
    v_fmac_f32 v100, v14, v8
    v_fmac_f32 v101, v15, v8
    v_lshlrev_b32 v14, 16, v71
    v_and_b32 v15, 0xffff0000, v71
    v_fmac_f32 v102, v14, v8
    v_fmac_f32 v103, v15, v8
    s_waitcnt vmcnt(3)
    v_lshlrev_b32 v14, 16, v72
    v_and_b32 v15, 0xffff0000, v72
    v_fmac_f32 v96, v14, v9
    v_fmac_f32 v97, v15, v9
    v_lshlrev_b32 v14, 16, v73
    v_and_b32 v15, 0xffff0000, v73
    v_fmac_f32 v98, v14, v9
    v_fmac_f32 v99, v15, v9
    v_lshlrev_b32 v14, 16, v74
    v_and_b32 v15, 0xffff0000, v74
    v_fmac_f32 v100, v14, v9
    v_fmac_f32 v101, v15, v9
    v_lshlrev_b32 v14, 16, v75
    v_and_b32 v15, 0xffff0000, v75
    v_fmac_f32 v102, v14, v9
    v_fmac_f32 v103, v15, v9
    s_waitcnt vmcnt(2)
    v_lshlrev_b32 v14, 16, v76
    v_and_b32 v15, 0xffff0000, v76
    v_fmac_f32 v96, v14, v10
    v_fmac_f32 v97, v15, v10
    v_lshlrev_b32 v14, 16, v77
    v_and_b32 v15, 0xffff0000, v77
    v_fmac_f32 v98, v14, v10
    v_fmac_f32 v99, v15, v10
    v_lshlrev_b32 v14, 16, v78
    v_and_b32 v15, 0xffff0000, v78
    v_fmac_f32 v100, v14, v10
    v_fmac_f32 v101, v15, v10
    v_lshlrev_b32 v14, 16, v79
    v_and_b32 v15, 0xffff0000, v79
    v_fmac_f32 v102, v14, v10
    v_fmac_f32 v103, v15, v10
    s_waitcnt vmcnt(1)
    v_lshlrev_b32 v14, 16, v80
    v_and_b32 v15, 0xffff0000, v80
    v_fmac_f32 v96, v14, v11
    v_fmac_f32 v97, v15, v11
    v_lshlrev_b32 v14, 16, v81
    v_and_b32 v15, 0xffff0000, v81
    v_fmac_f32 v98, v14, v11
    v_fmac_f32 v99, v15, v11
    v_lshlrev_b32 v14, 16, v82
    v_and_b32 v15, 0xffff0000, v82
    v_fmac_f32 v100, v14, v11
    v_fmac_f32 v101, v15, v11
    v_lshlrev_b32 v14, 16, v83
    v_and_b32 v15, 0xffff0000, v83
    v_fmac_f32 v102, v14, v11
    v_fmac_f32 v103, v15, v11
    s_waitcnt vmcnt(0)
    v_lshlrev_b32 v14, 16, v84
    v_and_b32 v15, 0xffff0000, v84
    v_fmac_f32 v96, v14, v12
    v_fmac_f32 v97, v15, v12
    v_lshlrev_b32 v14, 16, v85
    v_and_b32 v15, 0xffff0000, v85
    v_fmac_f32 v98, v14, v12
    v_fmac_f32 v99, v15, v12
    v_lshlrev_b32 v14, 16, v86
    v_and_b32 v15, 0xffff0000, v86
    v_fmac_f32 v100, v14, v12
    v_fmac_f32 v101, v15, v12
    v_lshlrev_b32 v14, 16, v87
    v_and_b32 v15, 0xffff0000, v87
    v_fmac_f32 v102, v14, v12
    v_fmac_f32 v103, v15, v12
    v_add_f32_dpp v88, v88, v88 row_ror:4 row_mask:0xf bank_mask:0xf
    v_add_f32_dpp v89, v89, v89 row_ror:4 row_mask:0xf bank_mask:0xf
    v_add_f32_dpp v90, v90, v90 row_ror:4 row_mask:0xf bank_mask:0xf
    v_add_f32_dpp v91, v91, v91 row_ror:4 row_mask:0xf bank_mask:0xf
    v_add_f32_dpp v92, v92, v92 row_ror:4 row_mask:0xf bank_mask:0xf
    v_add_f32_dpp v93, v93, v93 row_ror:4 row_mask:0xf bank_mask:0xf
    v_add_f32_dpp v94, v94, v94 row_ror:4 row_mask:0xf bank_mask:0xf
    v_add_f32_dpp v95, v95, v95 row_ror:4 row_mask:0xf bank_mask:0xf
    v_add_f32_dpp v96, v96, v96 row_ror:4 row_mask:0xf bank_mask:0xf
    v_add_f32_dpp v97, v97, v97 row_ror:4 row_mask:0xf bank_mask:0xf
    v_add_f32_dpp v98, v98, v98 row_ror:4 row_mask:0xf bank_mask:0xf
    v_add_f32_dpp v99, v99, v99 row_ror:4 row_mask:0xf bank_mask:0xf
    v_add_f32_dpp v100, v100, v100 row_ror:4 row_mask:0xf bank_mask:0xf
    v_add_f32_dpp v101, v101, v101 row_ror:4 row_mask:0xf bank_mask:0xf
    v_add_f32_dpp v102, v102, v102 row_ror:4 row_mask:0xf bank_mask:0xf
    v_add_f32_dpp v103, v103, v103 row_ror:4 row_mask:0xf bank_mask:0xf
    v_add_f32_dpp v88, v88, v88 row_ror:8 row_mask:0xf bank_mask:0xf
    v_add_f32_dpp v89, v89, v89 row_ror:8 row_mask:0xf bank_mask:0xf
    v_add_f32_dpp v90, v90, v90 row_ror:8 row_mask:0xf bank_mask:0xf
    v_add_f32_dpp v91, v91, v91 row_ror:8 row_mask:0xf bank_mask:0xf
    v_add_f32_dpp v92, v92, v92 row_ror:8 row_mask:0xf bank_mask:0xf
    v_add_f32_dpp v93, v93, v93 row_ror:8 row_mask:0xf bank_mask:0xf
    v_add_f32_dpp v94, v94, v94 row_ror:8 row_mask:0xf bank_mask:0xf
    v_add_f32_dpp v95, v95, v95 row_ror:8 row_mask:0xf bank_mask:0xf
    v_add_f32_dpp v96, v96, v96 row_ror:8 row_mask:0xf bank_mask:0xf
    v_add_f32_dpp v97, v97, v97 row_ror:8 row_mask:0xf bank_mask:0xf
    v_add_f32_dpp v98, v98, v98 row_ror:8 row_mask:0xf bank_mask:0xf
    v_add_f32_dpp v99, v99, v99 row_ror:8 row_mask:0xf bank_mask:0xf
    v_add_f32_dpp v100, v100, v100 row_ror:8 row_mask:0xf bank_mask:0xf
    v_add_f32_dpp v101, v101, v101 row_ror:8 row_mask:0xf bank_mask:0xf
    v_add_f32_dpp v102, v102, v102 row_ror:8 row_mask:0xf bank_mask:0xf
    v_add_f32_dpp v103, v103, v103 row_ror:8 row_mask:0xf bank_mask:0xf
    v_lshrrev_b32 v14, 4, v0
    v_lshlrev_b32 v14, 7, v14
    v_lshlrev_b32 v15, 5, v1
    v_add_u32 v14, v14, v15
    ds_write_b128 v14, v[88:91] offset:12288
    ds_write_b128 v14, v[92:95] offset:12304
    ds_write_b128 v14, v[96:99] offset:14336
    ds_write_b128 v14, v[100:103] offset:14352
    s_waitcnt lgkmcnt(0)
    s_barrier
    v_and_b32 v14, 31, v0
    v_lshlrev_b32 v14, 2, v14
    ds_read_b32 v20, v14 offset:12288
    ds_read_b32 v21, v14 offset:12416
    ds_read_b32 v22, v14 offset:12544
    ds_read_b32 v23, v14 offset:12672
    ds_read_b32 v24, v14 offset:12800
    ds_read_b32 v25, v14 offset:12928
    ds_read_b32 v26, v14 offset:13056
    ds_read_b32 v27, v14 offset:13184
    ds_read_b32 v28, v14 offset:13312
    ds_read_b32 v29, v14 offset:13440
    ds_read_b32 v30, v14 offset:13568
    ds_read_b32 v31, v14 offset:13696
    ds_read_b32 v32, v14 offset:13824
    ds_read_b32 v33, v14 offset:13952
    ds_read_b32 v34, v14 offset:14080
    ds_read_b32 v35, v14 offset:14208
    ds_read_b32 v36, v14 offset:14336
    ds_read_b32 v37, v14 offset:14464
    ds_read_b32 v38, v14 offset:14592
    ds_read_b32 v39, v14 offset:14720
    ds_read_b32 v40, v14 offset:14848
    ds_read_b32 v41, v14 offset:14976
    ds_read_b32 v42, v14 offset:15104
    ds_read_b32 v43, v14 offset:15232
    ds_read_b32 v44, v14 offset:15360
    ds_read_b32 v45, v14 offset:15488
    ds_read_b32 v46, v14 offset:15616
    ds_read_b32 v47, v14 offset:15744
    ds_read_b32 v48, v14 offset:15872
    ds_read_b32 v49, v14 offset:16000
    ds_read_b32 v50, v14 offset:16128
    ds_read_b32 v51, v14 offset:16256
    s_waitcnt lgkmcnt(0)
    v_add_f32 v20, v20, v21
    v_add_f32 v22, v22, v23
    v_add_f32 v24, v24, v25
    v_add_f32 v26, v26, v27
    v_add_f32 v28, v28, v29
    v_add_f32 v30, v30, v31
    v_add_f32 v32, v32, v33
    v_add_f32 v34, v34, v35
    v_add_f32 v20, v20, v22
    v_add_f32 v24, v24, v26
    v_add_f32 v28, v28, v30
    v_add_f32 v32, v32, v34
    v_add_f32 v20, v20, v24
    v_add_f32 v28, v28, v32
    v_add_f32 v20, v20, v28
    v_add_f32 v36, v36, v37
    v_add_f32 v38, v38, v39
    v_add_f32 v40, v40, v41
    v_add_f32 v42, v42, v43
    v_add_f32 v44, v44, v45
    v_add_f32 v46, v46, v47
    v_add_f32 v48, v48, v49
    v_add_f32 v50, v50, v51
    v_add_f32 v36, v36, v38
    v_add_f32 v40, v40, v42
    v_add_f32 v44, v44, v46
    v_add_f32 v48, v48, v50
    v_add_f32 v36, v36, v40
    v_add_f32 v44, v44, v48
    v_add_f32 v36, v36, v44
    v_cvt_pk_bf16_f32 v20, v20, v20
    v_and_b32 v20, 0xffff0000, v20
    v_cvt_pk_bf16_f32 v36, v36, v36
    v_and_b32 v36, 0xffff0000, v36
    v_mul_f32 v21, v20, v20
    v_mul_f32 v21, v21, v20
    v_mov_b32 v22, 0x3d372713
    v_fma_f32 v21, v21, v22, v20
    v_mul_f32 v21, 0x40135761, v21
    v_exp_f32 v21, v21
    s_nop 1
    v_add_f32 v21, 1.0, v21
    v_rcp_f32 v21, v21
    s_nop 1
    v_fma_f32 v21, v21, -2.0, 2.0
    v_mul_f32 v21, v21, v20
    v_mul_f32 v21, 0.5, v21
    v_cvt_pk_bf16_f32 v21, v21, v21
    v_and_b32 v21, 0xffff0000, v21
    v_mul_f32 v21, v21, v36
    v_cvt_pk_bf16_f32 v21, v21, v21
    v_and_b32 v21, 0xffff0000, v21
    v_lshlrev_b32 v22, 2, v0
    s_lshl_b32 s46, s46, 1
    s_add_u32 s46, s46, 8192
    v_add_u32 v22, s46, v22
    v_cmp_gt_u32 vcc, 32, v0
    s_and_saveexec_b64 s[44:45], vcc
    s_cbranch_execz K1_exit
    buffer_store_dword v21, v22, s[56:59], 0 offen
K1_exit:
    s_endpgm
.p2align 8
.globl k2_attn_kernel
.type k2_attn_kernel,@function
k2_attn_kernel:
    s_cmp_ge_u32 s2, 1024
    s_cbranch_scc1 K2_exit
    s_load_dwordx16 s[16:31], s[0:1], 0
    s_load_dwordx8 s[32:39], s[0:1], 64
    v_and_b32 v3, 63, v0
    v_lshlrev_b32 v1, 4, v3
    v_lshrrev_b32 v12, 6, v0
    v_lshlrev_b32 v12, 16, v12
    v_add_u32 v1, v1, v12
    v_add_u32 v2, 0x1000, v1
    v_and_b32 v3, 15, v0
    v_lshlrev_b32 v3, 4, v3
    s_lshr_b32 s57, s2, 6
    s_and_b32 s58, s2, 63
    s_lshl_b32 s54, s2, 18
    s_mov_b32 s55, s54
    s_mov_b32 s52, 0x05040100
    s_mov_b32 s53, 0x07060302
    s_mov_b32 s56, 0x3e0293ee
    s_waitcnt lgkmcnt(0)
    s_mov_b32 s40, s18
    s_and_b32 s41, s19, 0xffff
    s_mov_b32 s42, 268435456
    s_mov_b32 s43, 0x00020000
    s_mov_b32 s44, s20
    s_and_b32 s45, s21, 0xffff
    s_mov_b32 s46, 268435456
    s_mov_b32 s47, 0x00020000
    s_mov_b32 s48, s38
    s_and_b32 s49, s39, 0xffff
    s_mov_b32 s50, 1073741824
    s_mov_b32 s51, 0x00020000
    s_lshl_b32 s59, s57, 9
    buffer_load_dwordx4 v[4:7], v3, s[48:51], s59 offen
    buffer_load_dwordx4 v[8:11], v3, s[48:51], s59 offen offset:256
    buffer_load_dwordx4 v[16:19], v1, s[40:43], s54 offen offset:0 nt
    buffer_load_dwordx4 v[20:23], v1, s[40:43], s54 offen offset:1024 nt
    buffer_load_dwordx4 v[24:27], v1, s[40:43], s54 offen offset:2048 nt
    buffer_load_dwordx4 v[28:31], v1, s[40:43], s54 offen offset:3072 nt
    buffer_load_dwordx4 v[32:35], v2, s[40:43], s54 offen offset:0 nt
    buffer_load_dwordx4 v[36:39], v2, s[40:43], s54 offen offset:1024 nt
    buffer_load_dwordx4 v[40:43], v2, s[40:43], s54 offen offset:2048 nt
    buffer_load_dwordx4 v[44:47], v2, s[40:43], s54 offen offset:3072 nt
    buffer_load_dwordx4 v[48:51], v1, s[44:47], s55 offen offset:0 nt
    buffer_load_dwordx4 v[52:55], v1, s[44:47], s55 offen offset:1024 nt
    buffer_load_dwordx4 v[56:59], v1, s[44:47], s55 offen offset:2048 nt
    buffer_load_dwordx4 v[60:63], v1, s[44:47], s55 offen offset:3072 nt
    buffer_load_dwordx4 v[64:67], v2, s[44:47], s55 offen offset:0 nt
    buffer_load_dwordx4 v[68:71], v2, s[44:47], s55 offen offset:1024 nt
    buffer_load_dwordx4 v[72:75], v2, s[44:47], s55 offen offset:2048 nt
    buffer_load_dwordx4 v[76:79], v2, s[44:47], s55 offen offset:3072 nt
    v_mov_b32 v104, 0
    v_mov_b32 v105, 0
    v_mov_b32 v106, 0
    v_mov_b32 v107, 0
    v_mov_b32 v108, 0
    v_mov_b32 v109, 0
    v_mov_b32 v110, 0
    v_mov_b32 v111, 0
    v_mov_b32 v112, 0
    v_mov_b32 v113, 0
    v_mov_b32 v114, 0
    v_mov_b32 v115, 0
    v_mov_b32 v116, 0
    v_mov_b32 v117, 0
    v_mov_b32 v118, 0
    v_mov_b32 v119, 0
    v_mov_b32 v120, 0xff800000
    v_mov_b32 v121, 0xff800000
    v_mov_b32 v122, 0
    v_mov_b32 v123, 0
    s_waitcnt vmcnt(8)
    v_dot2_f32_bf16 v80, v16, v4, 0
    v_dot2_f32_bf16 v88, v16, v8, 0
    v_dot2_f32_bf16 v81, v20, v4, 0
    v_dot2_f32_bf16 v89, v20, v8, 0
    v_dot2_f32_bf16 v82, v24, v4, 0
    v_dot2_f32_bf16 v90, v24, v8, 0
    v_dot2_f32_bf16 v83, v28, v4, 0
    v_dot2_f32_bf16 v91, v28, v8, 0
    v_dot2_f32_bf16 v84, v32, v4, 0
    v_dot2_f32_bf16 v92, v32, v8, 0
    v_dot2_f32_bf16 v85, v36, v4, 0
    v_dot2_f32_bf16 v93, v36, v8, 0
    v_dot2_f32_bf16 v86, v40, v4, 0
    v_dot2_f32_bf16 v94, v40, v8, 0
    v_dot2_f32_bf16 v87, v44, v4, 0
    v_dot2_f32_bf16 v95, v44, v8, 0
    v_dot2c_f32_bf16 v80, v17, v5
    v_dot2c_f32_bf16 v88, v17, v9
    v_dot2c_f32_bf16 v81, v21, v5
    v_dot2c_f32_bf16 v89, v21, v9
    v_dot2c_f32_bf16 v82, v25, v5
    v_dot2c_f32_bf16 v90, v25, v9
    v_dot2c_f32_bf16 v83, v29, v5
    v_dot2c_f32_bf16 v91, v29, v9
    v_dot2c_f32_bf16 v84, v33, v5
    v_dot2c_f32_bf16 v92, v33, v9
    v_dot2c_f32_bf16 v85, v37, v5
    v_dot2c_f32_bf16 v93, v37, v9
    v_dot2c_f32_bf16 v86, v41, v5
    v_dot2c_f32_bf16 v94, v41, v9
    v_dot2c_f32_bf16 v87, v45, v5
    v_dot2c_f32_bf16 v95, v45, v9
    v_dot2c_f32_bf16 v80, v18, v6
    v_dot2c_f32_bf16 v88, v18, v10
    v_dot2c_f32_bf16 v81, v22, v6
    v_dot2c_f32_bf16 v89, v22, v10
    v_dot2c_f32_bf16 v82, v26, v6
    v_dot2c_f32_bf16 v90, v26, v10
    v_dot2c_f32_bf16 v83, v30, v6
    v_dot2c_f32_bf16 v91, v30, v10
    v_dot2c_f32_bf16 v84, v34, v6
    v_dot2c_f32_bf16 v92, v34, v10
    v_dot2c_f32_bf16 v85, v38, v6
    v_dot2c_f32_bf16 v93, v38, v10
    v_dot2c_f32_bf16 v86, v42, v6
    v_dot2c_f32_bf16 v94, v42, v10
    v_dot2c_f32_bf16 v87, v46, v6
    v_dot2c_f32_bf16 v95, v46, v10
    v_dot2c_f32_bf16 v80, v19, v7
    v_dot2c_f32_bf16 v88, v19, v11
    v_dot2c_f32_bf16 v81, v23, v7
    v_dot2c_f32_bf16 v89, v23, v11
    v_dot2c_f32_bf16 v82, v27, v7
    v_dot2c_f32_bf16 v90, v27, v11
    v_dot2c_f32_bf16 v83, v31, v7
    v_dot2c_f32_bf16 v91, v31, v11
    v_dot2c_f32_bf16 v84, v35, v7
    v_dot2c_f32_bf16 v92, v35, v11
    v_dot2c_f32_bf16 v85, v39, v7
    v_dot2c_f32_bf16 v93, v39, v11
    v_dot2c_f32_bf16 v86, v43, v7
    v_dot2c_f32_bf16 v94, v43, v11
    v_dot2c_f32_bf16 v87, v47, v7
    v_dot2c_f32_bf16 v95, v47, v11
    s_add_u32 s54, s54, 8192
    buffer_load_dwordx4 v[16:19], v1, s[40:43], s54 offen offset:0 nt
    buffer_load_dwordx4 v[20:23], v1, s[40:43], s54 offen offset:1024 nt
    buffer_load_dwordx4 v[24:27], v1, s[40:43], s54 offen offset:2048 nt
    buffer_load_dwordx4 v[28:31], v1, s[40:43], s54 offen offset:3072 nt
    buffer_load_dwordx4 v[32:35], v2, s[40:43], s54 offen offset:0 nt
    buffer_load_dwordx4 v[36:39], v2, s[40:43], s54 offen offset:1024 nt
    buffer_load_dwordx4 v[40:43], v2, s[40:43], s54 offen offset:2048 nt
    buffer_load_dwordx4 v[44:47], v2, s[40:43], s54 offen offset:3072 nt
    v_add_f32_dpp v80, v80, v80 row_ror:8 row_mask:0xf bank_mask:0xf
    v_add_f32_dpp v81, v81, v81 row_ror:8 row_mask:0xf bank_mask:0xf
    v_add_f32_dpp v82, v82, v82 row_ror:8 row_mask:0xf bank_mask:0xf
    v_add_f32_dpp v83, v83, v83 row_ror:8 row_mask:0xf bank_mask:0xf
    v_add_f32_dpp v84, v84, v84 row_ror:8 row_mask:0xf bank_mask:0xf
    v_add_f32_dpp v85, v85, v85 row_ror:8 row_mask:0xf bank_mask:0xf
    v_add_f32_dpp v86, v86, v86 row_ror:8 row_mask:0xf bank_mask:0xf
    v_add_f32_dpp v87, v87, v87 row_ror:8 row_mask:0xf bank_mask:0xf
    v_add_f32_dpp v88, v88, v88 row_ror:8 row_mask:0xf bank_mask:0xf
    v_add_f32_dpp v89, v89, v89 row_ror:8 row_mask:0xf bank_mask:0xf
    v_add_f32_dpp v90, v90, v90 row_ror:8 row_mask:0xf bank_mask:0xf
    v_add_f32_dpp v91, v91, v91 row_ror:8 row_mask:0xf bank_mask:0xf
    v_add_f32_dpp v92, v92, v92 row_ror:8 row_mask:0xf bank_mask:0xf
    v_add_f32_dpp v93, v93, v93 row_ror:8 row_mask:0xf bank_mask:0xf
    v_add_f32_dpp v94, v94, v94 row_ror:8 row_mask:0xf bank_mask:0xf
    v_add_f32_dpp v95, v95, v95 row_ror:8 row_mask:0xf bank_mask:0xf
    v_add_f32_dpp v80, v80, v80 row_ror:4 row_mask:0xf bank_mask:0xf
    v_add_f32_dpp v81, v81, v81 row_ror:4 row_mask:0xf bank_mask:0xf
    v_add_f32_dpp v82, v82, v82 row_ror:4 row_mask:0xf bank_mask:0xf
    v_add_f32_dpp v83, v83, v83 row_ror:4 row_mask:0xf bank_mask:0xf
    v_add_f32_dpp v84, v84, v84 row_ror:4 row_mask:0xf bank_mask:0xf
    v_add_f32_dpp v85, v85, v85 row_ror:4 row_mask:0xf bank_mask:0xf
    v_add_f32_dpp v86, v86, v86 row_ror:4 row_mask:0xf bank_mask:0xf
    v_add_f32_dpp v87, v87, v87 row_ror:4 row_mask:0xf bank_mask:0xf
    v_add_f32_dpp v88, v88, v88 row_ror:4 row_mask:0xf bank_mask:0xf
    v_add_f32_dpp v89, v89, v89 row_ror:4 row_mask:0xf bank_mask:0xf
    v_add_f32_dpp v90, v90, v90 row_ror:4 row_mask:0xf bank_mask:0xf
    v_add_f32_dpp v91, v91, v91 row_ror:4 row_mask:0xf bank_mask:0xf
    v_add_f32_dpp v92, v92, v92 row_ror:4 row_mask:0xf bank_mask:0xf
    v_add_f32_dpp v93, v93, v93 row_ror:4 row_mask:0xf bank_mask:0xf
    v_add_f32_dpp v94, v94, v94 row_ror:4 row_mask:0xf bank_mask:0xf
    v_add_f32_dpp v95, v95, v95 row_ror:4 row_mask:0xf bank_mask:0xf
    v_add_f32_dpp v80, v80, v80 row_ror:2 row_mask:0xf bank_mask:0xf
    v_add_f32_dpp v81, v81, v81 row_ror:2 row_mask:0xf bank_mask:0xf
    v_add_f32_dpp v82, v82, v82 row_ror:2 row_mask:0xf bank_mask:0xf
    v_add_f32_dpp v83, v83, v83 row_ror:2 row_mask:0xf bank_mask:0xf
    v_add_f32_dpp v84, v84, v84 row_ror:2 row_mask:0xf bank_mask:0xf
    v_add_f32_dpp v85, v85, v85 row_ror:2 row_mask:0xf bank_mask:0xf
    v_add_f32_dpp v86, v86, v86 row_ror:2 row_mask:0xf bank_mask:0xf
    v_add_f32_dpp v87, v87, v87 row_ror:2 row_mask:0xf bank_mask:0xf
    v_add_f32_dpp v88, v88, v88 row_ror:2 row_mask:0xf bank_mask:0xf
    v_add_f32_dpp v89, v89, v89 row_ror:2 row_mask:0xf bank_mask:0xf
    v_add_f32_dpp v90, v90, v90 row_ror:2 row_mask:0xf bank_mask:0xf
    v_add_f32_dpp v91, v91, v91 row_ror:2 row_mask:0xf bank_mask:0xf
    v_add_f32_dpp v92, v92, v92 row_ror:2 row_mask:0xf bank_mask:0xf
    v_add_f32_dpp v93, v93, v93 row_ror:2 row_mask:0xf bank_mask:0xf
    v_add_f32_dpp v94, v94, v94 row_ror:2 row_mask:0xf bank_mask:0xf
    v_add_f32_dpp v95, v95, v95 row_ror:2 row_mask:0xf bank_mask:0xf
    v_add_f32_dpp v80, v80, v80 row_ror:1 row_mask:0xf bank_mask:0xf
    v_add_f32_dpp v81, v81, v81 row_ror:1 row_mask:0xf bank_mask:0xf
    v_add_f32_dpp v82, v82, v82 row_ror:1 row_mask:0xf bank_mask:0xf
    v_add_f32_dpp v83, v83, v83 row_ror:1 row_mask:0xf bank_mask:0xf
    v_add_f32_dpp v84, v84, v84 row_ror:1 row_mask:0xf bank_mask:0xf
    v_add_f32_dpp v85, v85, v85 row_ror:1 row_mask:0xf bank_mask:0xf
    v_add_f32_dpp v86, v86, v86 row_ror:1 row_mask:0xf bank_mask:0xf
    v_add_f32_dpp v87, v87, v87 row_ror:1 row_mask:0xf bank_mask:0xf
    v_add_f32_dpp v88, v88, v88 row_ror:1 row_mask:0xf bank_mask:0xf
    v_add_f32_dpp v89, v89, v89 row_ror:1 row_mask:0xf bank_mask:0xf
    v_add_f32_dpp v90, v90, v90 row_ror:1 row_mask:0xf bank_mask:0xf
    v_add_f32_dpp v91, v91, v91 row_ror:1 row_mask:0xf bank_mask:0xf
    v_add_f32_dpp v92, v92, v92 row_ror:1 row_mask:0xf bank_mask:0xf
    v_add_f32_dpp v93, v93, v93 row_ror:1 row_mask:0xf bank_mask:0xf
    v_add_f32_dpp v94, v94, v94 row_ror:1 row_mask:0xf bank_mask:0xf
    v_add_f32_dpp v95, v95, v95 row_ror:1 row_mask:0xf bank_mask:0xf
    v_max3_f32 v12, v80, v81, v82
    v_max3_f32 v12, v12, v83, v84
    v_max3_f32 v12, v12, v85, v86
    v_max3_f32 v12, v12, v87, v120
    v_sub_f32 v13, v120, v12
    v_mul_f32 v13, s56, v13
    v_exp_f32 v13, v13
    v_mul_f32 v14, s56, v12
    v_mov_b32 v120, v12
    v_fma_f32 v80, v80, s56, -v14
    v_fma_f32 v81, v81, s56, -v14
    v_fma_f32 v82, v82, s56, -v14
    v_fma_f32 v83, v83, s56, -v14
    v_fma_f32 v84, v84, s56, -v14
    v_fma_f32 v85, v85, s56, -v14
    v_fma_f32 v86, v86, s56, -v14
    v_fma_f32 v87, v87, s56, -v14
    v_exp_f32 v80, v80
    v_exp_f32 v81, v81
    v_exp_f32 v82, v82
    v_exp_f32 v83, v83
    v_exp_f32 v84, v84
    v_exp_f32 v85, v85
    v_exp_f32 v86, v86
    v_exp_f32 v87, v87
    v_mul_f32 v122, v122, v13
    v_mul_f32 v104, v104, v13
    v_mul_f32 v105, v105, v13
    v_mul_f32 v106, v106, v13
    v_mul_f32 v107, v107, v13
    v_mul_f32 v108, v108, v13
    v_mul_f32 v109, v109, v13
    v_mul_f32 v110, v110, v13
    v_mul_f32 v111, v111, v13
    v_add_f32 v122, v122, v80
    v_add_f32 v122, v122, v81
    v_add_f32 v122, v122, v82
    v_add_f32 v122, v122, v83
    v_add_f32 v122, v122, v84
    v_add_f32 v122, v122, v85
    v_add_f32 v122, v122, v86
    v_add_f32 v122, v122, v87
    v_cvt_pk_bf16_f32 v96, v80, v81
    v_cvt_pk_bf16_f32 v97, v82, v83
    v_cvt_pk_bf16_f32 v98, v84, v85
    v_cvt_pk_bf16_f32 v99, v86, v87
    v_max3_f32 v12, v88, v89, v90
    v_max3_f32 v12, v12, v91, v92
    v_max3_f32 v12, v12, v93, v94
    v_max3_f32 v12, v12, v95, v121
    v_sub_f32 v13, v121, v12
    v_mul_f32 v13, s56, v13
    v_exp_f32 v13, v13
    v_mul_f32 v14, s56, v12
    v_mov_b32 v121, v12
    v_fma_f32 v88, v88, s56, -v14
    v_fma_f32 v89, v89, s56, -v14
    v_fma_f32 v90, v90, s56, -v14
    v_fma_f32 v91, v91, s56, -v14
    v_fma_f32 v92, v92, s56, -v14
    v_fma_f32 v93, v93, s56, -v14
    v_fma_f32 v94, v94, s56, -v14
    v_fma_f32 v95, v95, s56, -v14
    v_exp_f32 v88, v88
    v_exp_f32 v89, v89
    v_exp_f32 v90, v90
    v_exp_f32 v91, v91
    v_exp_f32 v92, v92
    v_exp_f32 v93, v93
    v_exp_f32 v94, v94
    v_exp_f32 v95, v95
    v_mul_f32 v123, v123, v13
    v_mul_f32 v112, v112, v13
    v_mul_f32 v113, v113, v13
    v_mul_f32 v114, v114, v13
    v_mul_f32 v115, v115, v13
    v_mul_f32 v116, v116, v13
    v_mul_f32 v117, v117, v13
    v_mul_f32 v118, v118, v13
    v_mul_f32 v119, v119, v13
    v_add_f32 v123, v123, v88
    v_add_f32 v123, v123, v89
    v_add_f32 v123, v123, v90
    v_add_f32 v123, v123, v91
    v_add_f32 v123, v123, v92
    v_add_f32 v123, v123, v93
    v_add_f32 v123, v123, v94
    v_add_f32 v123, v123, v95
    v_cvt_pk_bf16_f32 v100, v88, v89
    v_cvt_pk_bf16_f32 v101, v90, v91
    v_cvt_pk_bf16_f32 v102, v92, v93
    v_cvt_pk_bf16_f32 v103, v94, v95
    s_waitcnt vmcnt(8)
    v_perm_b32 v12, v52, v48, s52
    v_perm_b32 v13, v52, v48, s53
    v_dot2c_f32_bf16 v104, v12, v96
    v_dot2c_f32_bf16 v105, v13, v96
    v_dot2c_f32_bf16 v112, v12, v100
    v_dot2c_f32_bf16 v113, v13, v100
    v_perm_b32 v14, v53, v49, s52
    v_perm_b32 v15, v53, v49, s53
    v_dot2c_f32_bf16 v106, v14, v96
    v_dot2c_f32_bf16 v107, v15, v96
    v_dot2c_f32_bf16 v114, v14, v100
    v_dot2c_f32_bf16 v115, v15, v100
    v_perm_b32 v12, v54, v50, s52
    v_perm_b32 v13, v54, v50, s53
    v_dot2c_f32_bf16 v108, v12, v96
    v_dot2c_f32_bf16 v109, v13, v96
    v_dot2c_f32_bf16 v116, v12, v100
    v_dot2c_f32_bf16 v117, v13, v100
    v_perm_b32 v14, v55, v51, s52
    v_perm_b32 v15, v55, v51, s53
    v_dot2c_f32_bf16 v110, v14, v96
    v_dot2c_f32_bf16 v111, v15, v96
    v_dot2c_f32_bf16 v118, v14, v100
    v_dot2c_f32_bf16 v119, v15, v100
    v_perm_b32 v12, v60, v56, s52
    v_perm_b32 v13, v60, v56, s53
    v_dot2c_f32_bf16 v104, v12, v97
    v_dot2c_f32_bf16 v105, v13, v97
    v_dot2c_f32_bf16 v112, v12, v101
    v_dot2c_f32_bf16 v113, v13, v101
    v_perm_b32 v14, v61, v57, s52
    v_perm_b32 v15, v61, v57, s53
    v_dot2c_f32_bf16 v106, v14, v97
    v_dot2c_f32_bf16 v107, v15, v97
    v_dot2c_f32_bf16 v114, v14, v101
    v_dot2c_f32_bf16 v115, v15, v101
    v_perm_b32 v12, v62, v58, s52
    v_perm_b32 v13, v62, v58, s53
    v_dot2c_f32_bf16 v108, v12, v97
    v_dot2c_f32_bf16 v109, v13, v97
    v_dot2c_f32_bf16 v116, v12, v101
    v_dot2c_f32_bf16 v117, v13, v101
    v_perm_b32 v14, v63, v59, s52
    v_perm_b32 v15, v63, v59, s53
    v_dot2c_f32_bf16 v110, v14, v97
    v_dot2c_f32_bf16 v111, v15, v97
    v_dot2c_f32_bf16 v118, v14, v101
    v_dot2c_f32_bf16 v119, v15, v101
    v_perm_b32 v12, v68, v64, s52
    v_perm_b32 v13, v68, v64, s53
    v_dot2c_f32_bf16 v104, v12, v98
    v_dot2c_f32_bf16 v105, v13, v98
    v_dot2c_f32_bf16 v112, v12, v102
    v_dot2c_f32_bf16 v113, v13, v102
    v_perm_b32 v14, v69, v65, s52
    v_perm_b32 v15, v69, v65, s53
    v_dot2c_f32_bf16 v106, v14, v98
    v_dot2c_f32_bf16 v107, v15, v98
    v_dot2c_f32_bf16 v114, v14, v102
    v_dot2c_f32_bf16 v115, v15, v102
    v_perm_b32 v12, v70, v66, s52
    v_perm_b32 v13, v70, v66, s53
    v_dot2c_f32_bf16 v108, v12, v98
    v_dot2c_f32_bf16 v109, v13, v98
    v_dot2c_f32_bf16 v116, v12, v102
    v_dot2c_f32_bf16 v117, v13, v102
    v_perm_b32 v14, v71, v67, s52
    v_perm_b32 v15, v71, v67, s53
    v_dot2c_f32_bf16 v110, v14, v98
    v_dot2c_f32_bf16 v111, v15, v98
    v_dot2c_f32_bf16 v118, v14, v102
    v_dot2c_f32_bf16 v119, v15, v102
    v_perm_b32 v12, v76, v72, s52
    v_perm_b32 v13, v76, v72, s53
    v_dot2c_f32_bf16 v104, v12, v99
    v_dot2c_f32_bf16 v105, v13, v99
    v_dot2c_f32_bf16 v112, v12, v103
    v_dot2c_f32_bf16 v113, v13, v103
    v_perm_b32 v14, v77, v73, s52
    v_perm_b32 v15, v77, v73, s53
    v_dot2c_f32_bf16 v106, v14, v99
    v_dot2c_f32_bf16 v107, v15, v99
    v_dot2c_f32_bf16 v114, v14, v103
    v_dot2c_f32_bf16 v115, v15, v103
    v_perm_b32 v12, v78, v74, s52
    v_perm_b32 v13, v78, v74, s53
    v_dot2c_f32_bf16 v108, v12, v99
    v_dot2c_f32_bf16 v109, v13, v99
    v_dot2c_f32_bf16 v116, v12, v103
    v_dot2c_f32_bf16 v117, v13, v103
    v_perm_b32 v14, v79, v75, s52
    v_perm_b32 v15, v79, v75, s53
    v_dot2c_f32_bf16 v110, v14, v99
    v_dot2c_f32_bf16 v111, v15, v99
    v_dot2c_f32_bf16 v118, v14, v103
    v_dot2c_f32_bf16 v119, v15, v103
    s_add_u32 s55, s55, 8192
    buffer_load_dwordx4 v[48:51], v1, s[44:47], s55 offen offset:0 nt
    buffer_load_dwordx4 v[52:55], v1, s[44:47], s55 offen offset:1024 nt
    buffer_load_dwordx4 v[56:59], v1, s[44:47], s55 offen offset:2048 nt
    buffer_load_dwordx4 v[60:63], v1, s[44:47], s55 offen offset:3072 nt
    buffer_load_dwordx4 v[64:67], v2, s[44:47], s55 offen offset:0 nt
    buffer_load_dwordx4 v[68:71], v2, s[44:47], s55 offen offset:1024 nt
    buffer_load_dwordx4 v[72:75], v2, s[44:47], s55 offen offset:2048 nt
    buffer_load_dwordx4 v[76:79], v2, s[44:47], s55 offen offset:3072 nt
    s_waitcnt vmcnt(8)
    v_dot2_f32_bf16 v80, v16, v4, 0
    v_dot2_f32_bf16 v88, v16, v8, 0
    v_dot2_f32_bf16 v81, v20, v4, 0
    v_dot2_f32_bf16 v89, v20, v8, 0
    v_dot2_f32_bf16 v82, v24, v4, 0
    v_dot2_f32_bf16 v90, v24, v8, 0
    v_dot2_f32_bf16 v83, v28, v4, 0
    v_dot2_f32_bf16 v91, v28, v8, 0
    v_dot2_f32_bf16 v84, v32, v4, 0
    v_dot2_f32_bf16 v92, v32, v8, 0
    v_dot2_f32_bf16 v85, v36, v4, 0
    v_dot2_f32_bf16 v93, v36, v8, 0
    v_dot2_f32_bf16 v86, v40, v4, 0
    v_dot2_f32_bf16 v94, v40, v8, 0
    v_dot2_f32_bf16 v87, v44, v4, 0
    v_dot2_f32_bf16 v95, v44, v8, 0
    v_dot2c_f32_bf16 v80, v17, v5
    v_dot2c_f32_bf16 v88, v17, v9
    v_dot2c_f32_bf16 v81, v21, v5
    v_dot2c_f32_bf16 v89, v21, v9
    v_dot2c_f32_bf16 v82, v25, v5
    v_dot2c_f32_bf16 v90, v25, v9
    v_dot2c_f32_bf16 v83, v29, v5
    v_dot2c_f32_bf16 v91, v29, v9
    v_dot2c_f32_bf16 v84, v33, v5
    v_dot2c_f32_bf16 v92, v33, v9
    v_dot2c_f32_bf16 v85, v37, v5
    v_dot2c_f32_bf16 v93, v37, v9
    v_dot2c_f32_bf16 v86, v41, v5
    v_dot2c_f32_bf16 v94, v41, v9
    v_dot2c_f32_bf16 v87, v45, v5
    v_dot2c_f32_bf16 v95, v45, v9
    v_dot2c_f32_bf16 v80, v18, v6
    v_dot2c_f32_bf16 v88, v18, v10
    v_dot2c_f32_bf16 v81, v22, v6
    v_dot2c_f32_bf16 v89, v22, v10
    v_dot2c_f32_bf16 v82, v26, v6
    v_dot2c_f32_bf16 v90, v26, v10
    v_dot2c_f32_bf16 v83, v30, v6
    v_dot2c_f32_bf16 v91, v30, v10
    v_dot2c_f32_bf16 v84, v34, v6
    v_dot2c_f32_bf16 v92, v34, v10
    v_dot2c_f32_bf16 v85, v38, v6
    v_dot2c_f32_bf16 v93, v38, v10
    v_dot2c_f32_bf16 v86, v42, v6
    v_dot2c_f32_bf16 v94, v42, v10
    v_dot2c_f32_bf16 v87, v46, v6
    v_dot2c_f32_bf16 v95, v46, v10
    v_dot2c_f32_bf16 v80, v19, v7
    v_dot2c_f32_bf16 v88, v19, v11
    v_dot2c_f32_bf16 v81, v23, v7
    v_dot2c_f32_bf16 v89, v23, v11
    v_dot2c_f32_bf16 v82, v27, v7
    v_dot2c_f32_bf16 v90, v27, v11
    v_dot2c_f32_bf16 v83, v31, v7
    v_dot2c_f32_bf16 v91, v31, v11
    v_dot2c_f32_bf16 v84, v35, v7
    v_dot2c_f32_bf16 v92, v35, v11
    v_dot2c_f32_bf16 v85, v39, v7
    v_dot2c_f32_bf16 v93, v39, v11
    v_dot2c_f32_bf16 v86, v43, v7
    v_dot2c_f32_bf16 v94, v43, v11
    v_dot2c_f32_bf16 v87, v47, v7
    v_dot2c_f32_bf16 v95, v47, v11
    s_add_u32 s54, s54, 8192
    buffer_load_dwordx4 v[16:19], v1, s[40:43], s54 offen offset:0 nt
    buffer_load_dwordx4 v[20:23], v1, s[40:43], s54 offen offset:1024 nt
    buffer_load_dwordx4 v[24:27], v1, s[40:43], s54 offen offset:2048 nt
    buffer_load_dwordx4 v[28:31], v1, s[40:43], s54 offen offset:3072 nt
    buffer_load_dwordx4 v[32:35], v2, s[40:43], s54 offen offset:0 nt
    buffer_load_dwordx4 v[36:39], v2, s[40:43], s54 offen offset:1024 nt
    buffer_load_dwordx4 v[40:43], v2, s[40:43], s54 offen offset:2048 nt
    buffer_load_dwordx4 v[44:47], v2, s[40:43], s54 offen offset:3072 nt
    v_add_f32_dpp v80, v80, v80 row_ror:8 row_mask:0xf bank_mask:0xf
    v_add_f32_dpp v81, v81, v81 row_ror:8 row_mask:0xf bank_mask:0xf
    v_add_f32_dpp v82, v82, v82 row_ror:8 row_mask:0xf bank_mask:0xf
    v_add_f32_dpp v83, v83, v83 row_ror:8 row_mask:0xf bank_mask:0xf
    v_add_f32_dpp v84, v84, v84 row_ror:8 row_mask:0xf bank_mask:0xf
    v_add_f32_dpp v85, v85, v85 row_ror:8 row_mask:0xf bank_mask:0xf
    v_add_f32_dpp v86, v86, v86 row_ror:8 row_mask:0xf bank_mask:0xf
    v_add_f32_dpp v87, v87, v87 row_ror:8 row_mask:0xf bank_mask:0xf
    v_add_f32_dpp v88, v88, v88 row_ror:8 row_mask:0xf bank_mask:0xf
    v_add_f32_dpp v89, v89, v89 row_ror:8 row_mask:0xf bank_mask:0xf
    v_add_f32_dpp v90, v90, v90 row_ror:8 row_mask:0xf bank_mask:0xf
    v_add_f32_dpp v91, v91, v91 row_ror:8 row_mask:0xf bank_mask:0xf
    v_add_f32_dpp v92, v92, v92 row_ror:8 row_mask:0xf bank_mask:0xf
    v_add_f32_dpp v93, v93, v93 row_ror:8 row_mask:0xf bank_mask:0xf
    v_add_f32_dpp v94, v94, v94 row_ror:8 row_mask:0xf bank_mask:0xf
    v_add_f32_dpp v95, v95, v95 row_ror:8 row_mask:0xf bank_mask:0xf
    v_add_f32_dpp v80, v80, v80 row_ror:4 row_mask:0xf bank_mask:0xf
    v_add_f32_dpp v81, v81, v81 row_ror:4 row_mask:0xf bank_mask:0xf
    v_add_f32_dpp v82, v82, v82 row_ror:4 row_mask:0xf bank_mask:0xf
    v_add_f32_dpp v83, v83, v83 row_ror:4 row_mask:0xf bank_mask:0xf
    v_add_f32_dpp v84, v84, v84 row_ror:4 row_mask:0xf bank_mask:0xf
    v_add_f32_dpp v85, v85, v85 row_ror:4 row_mask:0xf bank_mask:0xf
    v_add_f32_dpp v86, v86, v86 row_ror:4 row_mask:0xf bank_mask:0xf
    v_add_f32_dpp v87, v87, v87 row_ror:4 row_mask:0xf bank_mask:0xf
    v_add_f32_dpp v88, v88, v88 row_ror:4 row_mask:0xf bank_mask:0xf
    v_add_f32_dpp v89, v89, v89 row_ror:4 row_mask:0xf bank_mask:0xf
    v_add_f32_dpp v90, v90, v90 row_ror:4 row_mask:0xf bank_mask:0xf
    v_add_f32_dpp v91, v91, v91 row_ror:4 row_mask:0xf bank_mask:0xf
    v_add_f32_dpp v92, v92, v92 row_ror:4 row_mask:0xf bank_mask:0xf
    v_add_f32_dpp v93, v93, v93 row_ror:4 row_mask:0xf bank_mask:0xf
    v_add_f32_dpp v94, v94, v94 row_ror:4 row_mask:0xf bank_mask:0xf
    v_add_f32_dpp v95, v95, v95 row_ror:4 row_mask:0xf bank_mask:0xf
    v_add_f32_dpp v80, v80, v80 row_ror:2 row_mask:0xf bank_mask:0xf
    v_add_f32_dpp v81, v81, v81 row_ror:2 row_mask:0xf bank_mask:0xf
    v_add_f32_dpp v82, v82, v82 row_ror:2 row_mask:0xf bank_mask:0xf
    v_add_f32_dpp v83, v83, v83 row_ror:2 row_mask:0xf bank_mask:0xf
    v_add_f32_dpp v84, v84, v84 row_ror:2 row_mask:0xf bank_mask:0xf
    v_add_f32_dpp v85, v85, v85 row_ror:2 row_mask:0xf bank_mask:0xf
    v_add_f32_dpp v86, v86, v86 row_ror:2 row_mask:0xf bank_mask:0xf
    v_add_f32_dpp v87, v87, v87 row_ror:2 row_mask:0xf bank_mask:0xf
    v_add_f32_dpp v88, v88, v88 row_ror:2 row_mask:0xf bank_mask:0xf
    v_add_f32_dpp v89, v89, v89 row_ror:2 row_mask:0xf bank_mask:0xf
    v_add_f32_dpp v90, v90, v90 row_ror:2 row_mask:0xf bank_mask:0xf
    v_add_f32_dpp v91, v91, v91 row_ror:2 row_mask:0xf bank_mask:0xf
    v_add_f32_dpp v92, v92, v92 row_ror:2 row_mask:0xf bank_mask:0xf
    v_add_f32_dpp v93, v93, v93 row_ror:2 row_mask:0xf bank_mask:0xf
    v_add_f32_dpp v94, v94, v94 row_ror:2 row_mask:0xf bank_mask:0xf
    v_add_f32_dpp v95, v95, v95 row_ror:2 row_mask:0xf bank_mask:0xf
    v_add_f32_dpp v80, v80, v80 row_ror:1 row_mask:0xf bank_mask:0xf
    v_add_f32_dpp v81, v81, v81 row_ror:1 row_mask:0xf bank_mask:0xf
    v_add_f32_dpp v82, v82, v82 row_ror:1 row_mask:0xf bank_mask:0xf
    v_add_f32_dpp v83, v83, v83 row_ror:1 row_mask:0xf bank_mask:0xf
    v_add_f32_dpp v84, v84, v84 row_ror:1 row_mask:0xf bank_mask:0xf
    v_add_f32_dpp v85, v85, v85 row_ror:1 row_mask:0xf bank_mask:0xf
    v_add_f32_dpp v86, v86, v86 row_ror:1 row_mask:0xf bank_mask:0xf
    v_add_f32_dpp v87, v87, v87 row_ror:1 row_mask:0xf bank_mask:0xf
    v_add_f32_dpp v88, v88, v88 row_ror:1 row_mask:0xf bank_mask:0xf
    v_add_f32_dpp v89, v89, v89 row_ror:1 row_mask:0xf bank_mask:0xf
    v_add_f32_dpp v90, v90, v90 row_ror:1 row_mask:0xf bank_mask:0xf
    v_add_f32_dpp v91, v91, v91 row_ror:1 row_mask:0xf bank_mask:0xf
    v_add_f32_dpp v92, v92, v92 row_ror:1 row_mask:0xf bank_mask:0xf
    v_add_f32_dpp v93, v93, v93 row_ror:1 row_mask:0xf bank_mask:0xf
    v_add_f32_dpp v94, v94, v94 row_ror:1 row_mask:0xf bank_mask:0xf
    v_add_f32_dpp v95, v95, v95 row_ror:1 row_mask:0xf bank_mask:0xf
    v_max3_f32 v12, v80, v81, v82
    v_max3_f32 v12, v12, v83, v84
    v_max3_f32 v12, v12, v85, v86
    v_max3_f32 v12, v12, v87, v120
    v_sub_f32 v13, v120, v12
    v_mul_f32 v13, s56, v13
    v_exp_f32 v13, v13
    v_mul_f32 v14, s56, v12
    v_mov_b32 v120, v12
    v_fma_f32 v80, v80, s56, -v14
    v_fma_f32 v81, v81, s56, -v14
    v_fma_f32 v82, v82, s56, -v14
    v_fma_f32 v83, v83, s56, -v14
    v_fma_f32 v84, v84, s56, -v14
    v_fma_f32 v85, v85, s56, -v14
    v_fma_f32 v86, v86, s56, -v14
    v_fma_f32 v87, v87, s56, -v14
    v_exp_f32 v80, v80
    v_exp_f32 v81, v81
    v_exp_f32 v82, v82
    v_exp_f32 v83, v83
    v_exp_f32 v84, v84
    v_exp_f32 v85, v85
    v_exp_f32 v86, v86
    v_exp_f32 v87, v87
    v_mul_f32 v122, v122, v13
    v_mul_f32 v104, v104, v13
    v_mul_f32 v105, v105, v13
    v_mul_f32 v106, v106, v13
    v_mul_f32 v107, v107, v13
    v_mul_f32 v108, v108, v13
    v_mul_f32 v109, v109, v13
    v_mul_f32 v110, v110, v13
    v_mul_f32 v111, v111, v13
    v_add_f32 v122, v122, v80
    v_add_f32 v122, v122, v81
    v_add_f32 v122, v122, v82
    v_add_f32 v122, v122, v83
    v_add_f32 v122, v122, v84
    v_add_f32 v122, v122, v85
    v_add_f32 v122, v122, v86
    v_add_f32 v122, v122, v87
    v_cvt_pk_bf16_f32 v96, v80, v81
    v_cvt_pk_bf16_f32 v97, v82, v83
    v_cvt_pk_bf16_f32 v98, v84, v85
    v_cvt_pk_bf16_f32 v99, v86, v87
    v_max3_f32 v12, v88, v89, v90
    v_max3_f32 v12, v12, v91, v92
    v_max3_f32 v12, v12, v93, v94
    v_max3_f32 v12, v12, v95, v121
    v_sub_f32 v13, v121, v12
    v_mul_f32 v13, s56, v13
    v_exp_f32 v13, v13
    v_mul_f32 v14, s56, v12
    v_mov_b32 v121, v12
    v_fma_f32 v88, v88, s56, -v14
    v_fma_f32 v89, v89, s56, -v14
    v_fma_f32 v90, v90, s56, -v14
    v_fma_f32 v91, v91, s56, -v14
    v_fma_f32 v92, v92, s56, -v14
    v_fma_f32 v93, v93, s56, -v14
    v_fma_f32 v94, v94, s56, -v14
    v_fma_f32 v95, v95, s56, -v14
    v_exp_f32 v88, v88
    v_exp_f32 v89, v89
    v_exp_f32 v90, v90
    v_exp_f32 v91, v91
    v_exp_f32 v92, v92
    v_exp_f32 v93, v93
    v_exp_f32 v94, v94
    v_exp_f32 v95, v95
    v_mul_f32 v123, v123, v13
    v_mul_f32 v112, v112, v13
    v_mul_f32 v113, v113, v13
    v_mul_f32 v114, v114, v13
    v_mul_f32 v115, v115, v13
    v_mul_f32 v116, v116, v13
    v_mul_f32 v117, v117, v13
    v_mul_f32 v118, v118, v13
    v_mul_f32 v119, v119, v13
    v_add_f32 v123, v123, v88
    v_add_f32 v123, v123, v89
    v_add_f32 v123, v123, v90
    v_add_f32 v123, v123, v91
    v_add_f32 v123, v123, v92
    v_add_f32 v123, v123, v93
    v_add_f32 v123, v123, v94
    v_add_f32 v123, v123, v95
    v_cvt_pk_bf16_f32 v100, v88, v89
    v_cvt_pk_bf16_f32 v101, v90, v91
    v_cvt_pk_bf16_f32 v102, v92, v93
    v_cvt_pk_bf16_f32 v103, v94, v95
    s_waitcnt vmcnt(8)
    v_perm_b32 v12, v52, v48, s52
    v_perm_b32 v13, v52, v48, s53
    v_dot2c_f32_bf16 v104, v12, v96
    v_dot2c_f32_bf16 v105, v13, v96
    v_dot2c_f32_bf16 v112, v12, v100
    v_dot2c_f32_bf16 v113, v13, v100
    v_perm_b32 v14, v53, v49, s52
    v_perm_b32 v15, v53, v49, s53
    v_dot2c_f32_bf16 v106, v14, v96
    v_dot2c_f32_bf16 v107, v15, v96
    v_dot2c_f32_bf16 v114, v14, v100
    v_dot2c_f32_bf16 v115, v15, v100
    v_perm_b32 v12, v54, v50, s52
    v_perm_b32 v13, v54, v50, s53
    v_dot2c_f32_bf16 v108, v12, v96
    v_dot2c_f32_bf16 v109, v13, v96
    v_dot2c_f32_bf16 v116, v12, v100
    v_dot2c_f32_bf16 v117, v13, v100
    v_perm_b32 v14, v55, v51, s52
    v_perm_b32 v15, v55, v51, s53
    v_dot2c_f32_bf16 v110, v14, v96
    v_dot2c_f32_bf16 v111, v15, v96
    v_dot2c_f32_bf16 v118, v14, v100
    v_dot2c_f32_bf16 v119, v15, v100
    v_perm_b32 v12, v60, v56, s52
    v_perm_b32 v13, v60, v56, s53
    v_dot2c_f32_bf16 v104, v12, v97
    v_dot2c_f32_bf16 v105, v13, v97
    v_dot2c_f32_bf16 v112, v12, v101
    v_dot2c_f32_bf16 v113, v13, v101
    v_perm_b32 v14, v61, v57, s52
    v_perm_b32 v15, v61, v57, s53
    v_dot2c_f32_bf16 v106, v14, v97
    v_dot2c_f32_bf16 v107, v15, v97
    v_dot2c_f32_bf16 v114, v14, v101
    v_dot2c_f32_bf16 v115, v15, v101
    v_perm_b32 v12, v62, v58, s52
    v_perm_b32 v13, v62, v58, s53
    v_dot2c_f32_bf16 v108, v12, v97
    v_dot2c_f32_bf16 v109, v13, v97
    v_dot2c_f32_bf16 v116, v12, v101
    v_dot2c_f32_bf16 v117, v13, v101
    v_perm_b32 v14, v63, v59, s52
    v_perm_b32 v15, v63, v59, s53
    v_dot2c_f32_bf16 v110, v14, v97
    v_dot2c_f32_bf16 v111, v15, v97
    v_dot2c_f32_bf16 v118, v14, v101
    v_dot2c_f32_bf16 v119, v15, v101
    v_perm_b32 v12, v68, v64, s52
    v_perm_b32 v13, v68, v64, s53
    v_dot2c_f32_bf16 v104, v12, v98
    v_dot2c_f32_bf16 v105, v13, v98
    v_dot2c_f32_bf16 v112, v12, v102
    v_dot2c_f32_bf16 v113, v13, v102
    v_perm_b32 v14, v69, v65, s52
    v_perm_b32 v15, v69, v65, s53
    v_dot2c_f32_bf16 v106, v14, v98
    v_dot2c_f32_bf16 v107, v15, v98
    v_dot2c_f32_bf16 v114, v14, v102
    v_dot2c_f32_bf16 v115, v15, v102
    v_perm_b32 v12, v70, v66, s52
    v_perm_b32 v13, v70, v66, s53
    v_dot2c_f32_bf16 v108, v12, v98
    v_dot2c_f32_bf16 v109, v13, v98
    v_dot2c_f32_bf16 v116, v12, v102
    v_dot2c_f32_bf16 v117, v13, v102
    v_perm_b32 v14, v71, v67, s52
    v_perm_b32 v15, v71, v67, s53
    v_dot2c_f32_bf16 v110, v14, v98
    v_dot2c_f32_bf16 v111, v15, v98
    v_dot2c_f32_bf16 v118, v14, v102
    v_dot2c_f32_bf16 v119, v15, v102
    v_perm_b32 v12, v76, v72, s52
    v_perm_b32 v13, v76, v72, s53
    v_dot2c_f32_bf16 v104, v12, v99
    v_dot2c_f32_bf16 v105, v13, v99
    v_dot2c_f32_bf16 v112, v12, v103
    v_dot2c_f32_bf16 v113, v13, v103
    v_perm_b32 v14, v77, v73, s52
    v_perm_b32 v15, v77, v73, s53
    v_dot2c_f32_bf16 v106, v14, v99
    v_dot2c_f32_bf16 v107, v15, v99
    v_dot2c_f32_bf16 v114, v14, v103
    v_dot2c_f32_bf16 v115, v15, v103
    v_perm_b32 v12, v78, v74, s52
    v_perm_b32 v13, v78, v74, s53
    v_dot2c_f32_bf16 v108, v12, v99
    v_dot2c_f32_bf16 v109, v13, v99
    v_dot2c_f32_bf16 v116, v12, v103
    v_dot2c_f32_bf16 v117, v13, v103
    v_perm_b32 v14, v79, v75, s52
    v_perm_b32 v15, v79, v75, s53
    v_dot2c_f32_bf16 v110, v14, v99
    v_dot2c_f32_bf16 v111, v15, v99
    v_dot2c_f32_bf16 v118, v14, v103
    v_dot2c_f32_bf16 v119, v15, v103
    s_add_u32 s55, s55, 8192
    buffer_load_dwordx4 v[48:51], v1, s[44:47], s55 offen offset:0 nt
    buffer_load_dwordx4 v[52:55], v1, s[44:47], s55 offen offset:1024 nt
    buffer_load_dwordx4 v[56:59], v1, s[44:47], s55 offen offset:2048 nt
    buffer_load_dwordx4 v[60:63], v1, s[44:47], s55 offen offset:3072 nt
    buffer_load_dwordx4 v[64:67], v2, s[44:47], s55 offen offset:0 nt
    buffer_load_dwordx4 v[68:71], v2, s[44:47], s55 offen offset:1024 nt
    buffer_load_dwordx4 v[72:75], v2, s[44:47], s55 offen offset:2048 nt
    buffer_load_dwordx4 v[76:79], v2, s[44:47], s55 offen offset:3072 nt
    s_waitcnt vmcnt(8)
    v_dot2_f32_bf16 v80, v16, v4, 0
    v_dot2_f32_bf16 v88, v16, v8, 0
    v_dot2_f32_bf16 v81, v20, v4, 0
    v_dot2_f32_bf16 v89, v20, v8, 0
    v_dot2_f32_bf16 v82, v24, v4, 0
    v_dot2_f32_bf16 v90, v24, v8, 0
    v_dot2_f32_bf16 v83, v28, v4, 0
    v_dot2_f32_bf16 v91, v28, v8, 0
    v_dot2_f32_bf16 v84, v32, v4, 0
    v_dot2_f32_bf16 v92, v32, v8, 0
    v_dot2_f32_bf16 v85, v36, v4, 0
    v_dot2_f32_bf16 v93, v36, v8, 0
    v_dot2_f32_bf16 v86, v40, v4, 0
    v_dot2_f32_bf16 v94, v40, v8, 0
    v_dot2_f32_bf16 v87, v44, v4, 0
    v_dot2_f32_bf16 v95, v44, v8, 0
    v_dot2c_f32_bf16 v80, v17, v5
    v_dot2c_f32_bf16 v88, v17, v9
    v_dot2c_f32_bf16 v81, v21, v5
    v_dot2c_f32_bf16 v89, v21, v9
    v_dot2c_f32_bf16 v82, v25, v5
    v_dot2c_f32_bf16 v90, v25, v9
    v_dot2c_f32_bf16 v83, v29, v5
    v_dot2c_f32_bf16 v91, v29, v9
    v_dot2c_f32_bf16 v84, v33, v5
    v_dot2c_f32_bf16 v92, v33, v9
    v_dot2c_f32_bf16 v85, v37, v5
    v_dot2c_f32_bf16 v93, v37, v9
    v_dot2c_f32_bf16 v86, v41, v5
    v_dot2c_f32_bf16 v94, v41, v9
    v_dot2c_f32_bf16 v87, v45, v5
    v_dot2c_f32_bf16 v95, v45, v9
    v_dot2c_f32_bf16 v80, v18, v6
    v_dot2c_f32_bf16 v88, v18, v10
    v_dot2c_f32_bf16 v81, v22, v6
    v_dot2c_f32_bf16 v89, v22, v10
    v_dot2c_f32_bf16 v82, v26, v6
    v_dot2c_f32_bf16 v90, v26, v10
    v_dot2c_f32_bf16 v83, v30, v6
    v_dot2c_f32_bf16 v91, v30, v10
    v_dot2c_f32_bf16 v84, v34, v6
    v_dot2c_f32_bf16 v92, v34, v10
    v_dot2c_f32_bf16 v85, v38, v6
    v_dot2c_f32_bf16 v93, v38, v10
    v_dot2c_f32_bf16 v86, v42, v6
    v_dot2c_f32_bf16 v94, v42, v10
    v_dot2c_f32_bf16 v87, v46, v6
    v_dot2c_f32_bf16 v95, v46, v10
    v_dot2c_f32_bf16 v80, v19, v7
    v_dot2c_f32_bf16 v88, v19, v11
    v_dot2c_f32_bf16 v81, v23, v7
    v_dot2c_f32_bf16 v89, v23, v11
    v_dot2c_f32_bf16 v82, v27, v7
    v_dot2c_f32_bf16 v90, v27, v11
    v_dot2c_f32_bf16 v83, v31, v7
    v_dot2c_f32_bf16 v91, v31, v11
    v_dot2c_f32_bf16 v84, v35, v7
    v_dot2c_f32_bf16 v92, v35, v11
    v_dot2c_f32_bf16 v85, v39, v7
    v_dot2c_f32_bf16 v93, v39, v11
    v_dot2c_f32_bf16 v86, v43, v7
    v_dot2c_f32_bf16 v94, v43, v11
    v_dot2c_f32_bf16 v87, v47, v7
    v_dot2c_f32_bf16 v95, v47, v11
    s_add_u32 s54, s54, 8192
    buffer_load_dwordx4 v[16:19], v1, s[40:43], s54 offen offset:0 nt
    buffer_load_dwordx4 v[20:23], v1, s[40:43], s54 offen offset:1024 nt
    buffer_load_dwordx4 v[24:27], v1, s[40:43], s54 offen offset:2048 nt
    buffer_load_dwordx4 v[28:31], v1, s[40:43], s54 offen offset:3072 nt
    buffer_load_dwordx4 v[32:35], v2, s[40:43], s54 offen offset:0 nt
    buffer_load_dwordx4 v[36:39], v2, s[40:43], s54 offen offset:1024 nt
    buffer_load_dwordx4 v[40:43], v2, s[40:43], s54 offen offset:2048 nt
    buffer_load_dwordx4 v[44:47], v2, s[40:43], s54 offen offset:3072 nt
    v_add_f32_dpp v80, v80, v80 row_ror:8 row_mask:0xf bank_mask:0xf
    v_add_f32_dpp v81, v81, v81 row_ror:8 row_mask:0xf bank_mask:0xf
    v_add_f32_dpp v82, v82, v82 row_ror:8 row_mask:0xf bank_mask:0xf
    v_add_f32_dpp v83, v83, v83 row_ror:8 row_mask:0xf bank_mask:0xf
    v_add_f32_dpp v84, v84, v84 row_ror:8 row_mask:0xf bank_mask:0xf
    v_add_f32_dpp v85, v85, v85 row_ror:8 row_mask:0xf bank_mask:0xf
    v_add_f32_dpp v86, v86, v86 row_ror:8 row_mask:0xf bank_mask:0xf
    v_add_f32_dpp v87, v87, v87 row_ror:8 row_mask:0xf bank_mask:0xf
    v_add_f32_dpp v88, v88, v88 row_ror:8 row_mask:0xf bank_mask:0xf
    v_add_f32_dpp v89, v89, v89 row_ror:8 row_mask:0xf bank_mask:0xf
    v_add_f32_dpp v90, v90, v90 row_ror:8 row_mask:0xf bank_mask:0xf
    v_add_f32_dpp v91, v91, v91 row_ror:8 row_mask:0xf bank_mask:0xf
    v_add_f32_dpp v92, v92, v92 row_ror:8 row_mask:0xf bank_mask:0xf
    v_add_f32_dpp v93, v93, v93 row_ror:8 row_mask:0xf bank_mask:0xf
    v_add_f32_dpp v94, v94, v94 row_ror:8 row_mask:0xf bank_mask:0xf
    v_add_f32_dpp v95, v95, v95 row_ror:8 row_mask:0xf bank_mask:0xf
    v_add_f32_dpp v80, v80, v80 row_ror:4 row_mask:0xf bank_mask:0xf
    v_add_f32_dpp v81, v81, v81 row_ror:4 row_mask:0xf bank_mask:0xf
    v_add_f32_dpp v82, v82, v82 row_ror:4 row_mask:0xf bank_mask:0xf
    v_add_f32_dpp v83, v83, v83 row_ror:4 row_mask:0xf bank_mask:0xf
    v_add_f32_dpp v84, v84, v84 row_ror:4 row_mask:0xf bank_mask:0xf
    v_add_f32_dpp v85, v85, v85 row_ror:4 row_mask:0xf bank_mask:0xf
    v_add_f32_dpp v86, v86, v86 row_ror:4 row_mask:0xf bank_mask:0xf
    v_add_f32_dpp v87, v87, v87 row_ror:4 row_mask:0xf bank_mask:0xf
    v_add_f32_dpp v88, v88, v88 row_ror:4 row_mask:0xf bank_mask:0xf
    v_add_f32_dpp v89, v89, v89 row_ror:4 row_mask:0xf bank_mask:0xf
    v_add_f32_dpp v90, v90, v90 row_ror:4 row_mask:0xf bank_mask:0xf
    v_add_f32_dpp v91, v91, v91 row_ror:4 row_mask:0xf bank_mask:0xf
    v_add_f32_dpp v92, v92, v92 row_ror:4 row_mask:0xf bank_mask:0xf
    v_add_f32_dpp v93, v93, v93 row_ror:4 row_mask:0xf bank_mask:0xf
    v_add_f32_dpp v94, v94, v94 row_ror:4 row_mask:0xf bank_mask:0xf
    v_add_f32_dpp v95, v95, v95 row_ror:4 row_mask:0xf bank_mask:0xf
    v_add_f32_dpp v80, v80, v80 row_ror:2 row_mask:0xf bank_mask:0xf
    v_add_f32_dpp v81, v81, v81 row_ror:2 row_mask:0xf bank_mask:0xf
    v_add_f32_dpp v82, v82, v82 row_ror:2 row_mask:0xf bank_mask:0xf
    v_add_f32_dpp v83, v83, v83 row_ror:2 row_mask:0xf bank_mask:0xf
    v_add_f32_dpp v84, v84, v84 row_ror:2 row_mask:0xf bank_mask:0xf
    v_add_f32_dpp v85, v85, v85 row_ror:2 row_mask:0xf bank_mask:0xf
    v_add_f32_dpp v86, v86, v86 row_ror:2 row_mask:0xf bank_mask:0xf
    v_add_f32_dpp v87, v87, v87 row_ror:2 row_mask:0xf bank_mask:0xf
    v_add_f32_dpp v88, v88, v88 row_ror:2 row_mask:0xf bank_mask:0xf
    v_add_f32_dpp v89, v89, v89 row_ror:2 row_mask:0xf bank_mask:0xf
    v_add_f32_dpp v90, v90, v90 row_ror:2 row_mask:0xf bank_mask:0xf
    v_add_f32_dpp v91, v91, v91 row_ror:2 row_mask:0xf bank_mask:0xf
    v_add_f32_dpp v92, v92, v92 row_ror:2 row_mask:0xf bank_mask:0xf
    v_add_f32_dpp v93, v93, v93 row_ror:2 row_mask:0xf bank_mask:0xf
    v_add_f32_dpp v94, v94, v94 row_ror:2 row_mask:0xf bank_mask:0xf
    v_add_f32_dpp v95, v95, v95 row_ror:2 row_mask:0xf bank_mask:0xf
    v_add_f32_dpp v80, v80, v80 row_ror:1 row_mask:0xf bank_mask:0xf
    v_add_f32_dpp v81, v81, v81 row_ror:1 row_mask:0xf bank_mask:0xf
    v_add_f32_dpp v82, v82, v82 row_ror:1 row_mask:0xf bank_mask:0xf
    v_add_f32_dpp v83, v83, v83 row_ror:1 row_mask:0xf bank_mask:0xf
    v_add_f32_dpp v84, v84, v84 row_ror:1 row_mask:0xf bank_mask:0xf
    v_add_f32_dpp v85, v85, v85 row_ror:1 row_mask:0xf bank_mask:0xf
    v_add_f32_dpp v86, v86, v86 row_ror:1 row_mask:0xf bank_mask:0xf
    v_add_f32_dpp v87, v87, v87 row_ror:1 row_mask:0xf bank_mask:0xf
    v_add_f32_dpp v88, v88, v88 row_ror:1 row_mask:0xf bank_mask:0xf
    v_add_f32_dpp v89, v89, v89 row_ror:1 row_mask:0xf bank_mask:0xf
    v_add_f32_dpp v90, v90, v90 row_ror:1 row_mask:0xf bank_mask:0xf
    v_add_f32_dpp v91, v91, v91 row_ror:1 row_mask:0xf bank_mask:0xf
    v_add_f32_dpp v92, v92, v92 row_ror:1 row_mask:0xf bank_mask:0xf
    v_add_f32_dpp v93, v93, v93 row_ror:1 row_mask:0xf bank_mask:0xf
    v_add_f32_dpp v94, v94, v94 row_ror:1 row_mask:0xf bank_mask:0xf
    v_add_f32_dpp v95, v95, v95 row_ror:1 row_mask:0xf bank_mask:0xf
    v_max3_f32 v12, v80, v81, v82
    v_max3_f32 v12, v12, v83, v84
    v_max3_f32 v12, v12, v85, v86
    v_max3_f32 v12, v12, v87, v120
    v_sub_f32 v13, v120, v12
    v_mul_f32 v13, s56, v13
    v_exp_f32 v13, v13
    v_mul_f32 v14, s56, v12
    v_mov_b32 v120, v12
    v_fma_f32 v80, v80, s56, -v14
    v_fma_f32 v81, v81, s56, -v14
    v_fma_f32 v82, v82, s56, -v14
    v_fma_f32 v83, v83, s56, -v14
    v_fma_f32 v84, v84, s56, -v14
    v_fma_f32 v85, v85, s56, -v14
    v_fma_f32 v86, v86, s56, -v14
    v_fma_f32 v87, v87, s56, -v14
    v_exp_f32 v80, v80
    v_exp_f32 v81, v81
    v_exp_f32 v82, v82
    v_exp_f32 v83, v83
    v_exp_f32 v84, v84
    v_exp_f32 v85, v85
    v_exp_f32 v86, v86
    v_exp_f32 v87, v87
    v_mul_f32 v122, v122, v13
    v_mul_f32 v104, v104, v13
    v_mul_f32 v105, v105, v13
    v_mul_f32 v106, v106, v13
    v_mul_f32 v107, v107, v13
    v_mul_f32 v108, v108, v13
    v_mul_f32 v109, v109, v13
    v_mul_f32 v110, v110, v13
    v_mul_f32 v111, v111, v13
    v_add_f32 v122, v122, v80
    v_add_f32 v122, v122, v81
    v_add_f32 v122, v122, v82
    v_add_f32 v122, v122, v83
    v_add_f32 v122, v122, v84
    v_add_f32 v122, v122, v85
    v_add_f32 v122, v122, v86
    v_add_f32 v122, v122, v87
    v_cvt_pk_bf16_f32 v96, v80, v81
    v_cvt_pk_bf16_f32 v97, v82, v83
    v_cvt_pk_bf16_f32 v98, v84, v85
    v_cvt_pk_bf16_f32 v99, v86, v87
    v_max3_f32 v12, v88, v89, v90
    v_max3_f32 v12, v12, v91, v92
    v_max3_f32 v12, v12, v93, v94
    v_max3_f32 v12, v12, v95, v121
    v_sub_f32 v13, v121, v12
    v_mul_f32 v13, s56, v13
    v_exp_f32 v13, v13
    v_mul_f32 v14, s56, v12
    v_mov_b32 v121, v12
    v_fma_f32 v88, v88, s56, -v14
    v_fma_f32 v89, v89, s56, -v14
    v_fma_f32 v90, v90, s56, -v14
    v_fma_f32 v91, v91, s56, -v14
    v_fma_f32 v92, v92, s56, -v14
    v_fma_f32 v93, v93, s56, -v14
    v_fma_f32 v94, v94, s56, -v14
    v_fma_f32 v95, v95, s56, -v14
    v_exp_f32 v88, v88
    v_exp_f32 v89, v89
    v_exp_f32 v90, v90
    v_exp_f32 v91, v91
    v_exp_f32 v92, v92
    v_exp_f32 v93, v93
    v_exp_f32 v94, v94
    v_exp_f32 v95, v95
    v_mul_f32 v123, v123, v13
    v_mul_f32 v112, v112, v13
    v_mul_f32 v113, v113, v13
    v_mul_f32 v114, v114, v13
    v_mul_f32 v115, v115, v13
    v_mul_f32 v116, v116, v13
    v_mul_f32 v117, v117, v13
    v_mul_f32 v118, v118, v13
    v_mul_f32 v119, v119, v13
    v_add_f32 v123, v123, v88
    v_add_f32 v123, v123, v89
    v_add_f32 v123, v123, v90
    v_add_f32 v123, v123, v91
    v_add_f32 v123, v123, v92
    v_add_f32 v123, v123, v93
    v_add_f32 v123, v123, v94
    v_add_f32 v123, v123, v95
    v_cvt_pk_bf16_f32 v100, v88, v89
    v_cvt_pk_bf16_f32 v101, v90, v91
    v_cvt_pk_bf16_f32 v102, v92, v93
    v_cvt_pk_bf16_f32 v103, v94, v95
    s_waitcnt vmcnt(8)
    v_perm_b32 v12, v52, v48, s52
    v_perm_b32 v13, v52, v48, s53
    v_dot2c_f32_bf16 v104, v12, v96
    v_dot2c_f32_bf16 v105, v13, v96
    v_dot2c_f32_bf16 v112, v12, v100
    v_dot2c_f32_bf16 v113, v13, v100
    v_perm_b32 v14, v53, v49, s52
    v_perm_b32 v15, v53, v49, s53
    v_dot2c_f32_bf16 v106, v14, v96
    v_dot2c_f32_bf16 v107, v15, v96
    v_dot2c_f32_bf16 v114, v14, v100
    v_dot2c_f32_bf16 v115, v15, v100
    v_perm_b32 v12, v54, v50, s52
    v_perm_b32 v13, v54, v50, s53
    v_dot2c_f32_bf16 v108, v12, v96
    v_dot2c_f32_bf16 v109, v13, v96
    v_dot2c_f32_bf16 v116, v12, v100
    v_dot2c_f32_bf16 v117, v13, v100
    v_perm_b32 v14, v55, v51, s52
    v_perm_b32 v15, v55, v51, s53
    v_dot2c_f32_bf16 v110, v14, v96
    v_dot2c_f32_bf16 v111, v15, v96
    v_dot2c_f32_bf16 v118, v14, v100
    v_dot2c_f32_bf16 v119, v15, v100
    v_perm_b32 v12, v60, v56, s52
    v_perm_b32 v13, v60, v56, s53
    v_dot2c_f32_bf16 v104, v12, v97
    v_dot2c_f32_bf16 v105, v13, v97
    v_dot2c_f32_bf16 v112, v12, v101
    v_dot2c_f32_bf16 v113, v13, v101
    v_perm_b32 v14, v61, v57, s52
    v_perm_b32 v15, v61, v57, s53
    v_dot2c_f32_bf16 v106, v14, v97
    v_dot2c_f32_bf16 v107, v15, v97
    v_dot2c_f32_bf16 v114, v14, v101
    v_dot2c_f32_bf16 v115, v15, v101
    v_perm_b32 v12, v62, v58, s52
    v_perm_b32 v13, v62, v58, s53
    v_dot2c_f32_bf16 v108, v12, v97
    v_dot2c_f32_bf16 v109, v13, v97
    v_dot2c_f32_bf16 v116, v12, v101
    v_dot2c_f32_bf16 v117, v13, v101
    v_perm_b32 v14, v63, v59, s52
    v_perm_b32 v15, v63, v59, s53
    v_dot2c_f32_bf16 v110, v14, v97
    v_dot2c_f32_bf16 v111, v15, v97
    v_dot2c_f32_bf16 v118, v14, v101
    v_dot2c_f32_bf16 v119, v15, v101
    v_perm_b32 v12, v68, v64, s52
    v_perm_b32 v13, v68, v64, s53
    v_dot2c_f32_bf16 v104, v12, v98
    v_dot2c_f32_bf16 v105, v13, v98
    v_dot2c_f32_bf16 v112, v12, v102
    v_dot2c_f32_bf16 v113, v13, v102
    v_perm_b32 v14, v69, v65, s52
    v_perm_b32 v15, v69, v65, s53
    v_dot2c_f32_bf16 v106, v14, v98
    v_dot2c_f32_bf16 v107, v15, v98
    v_dot2c_f32_bf16 v114, v14, v102
    v_dot2c_f32_bf16 v115, v15, v102
    v_perm_b32 v12, v70, v66, s52
    v_perm_b32 v13, v70, v66, s53
    v_dot2c_f32_bf16 v108, v12, v98
    v_dot2c_f32_bf16 v109, v13, v98
    v_dot2c_f32_bf16 v116, v12, v102
    v_dot2c_f32_bf16 v117, v13, v102
    v_perm_b32 v14, v71, v67, s52
    v_perm_b32 v15, v71, v67, s53
    v_dot2c_f32_bf16 v110, v14, v98
    v_dot2c_f32_bf16 v111, v15, v98
    v_dot2c_f32_bf16 v118, v14, v102
    v_dot2c_f32_bf16 v119, v15, v102
    v_perm_b32 v12, v76, v72, s52
    v_perm_b32 v13, v76, v72, s53
    v_dot2c_f32_bf16 v104, v12, v99
    v_dot2c_f32_bf16 v105, v13, v99
    v_dot2c_f32_bf16 v112, v12, v103
    v_dot2c_f32_bf16 v113, v13, v103
    v_perm_b32 v14, v77, v73, s52
    v_perm_b32 v15, v77, v73, s53
    v_dot2c_f32_bf16 v106, v14, v99
    v_dot2c_f32_bf16 v107, v15, v99
    v_dot2c_f32_bf16 v114, v14, v103
    v_dot2c_f32_bf16 v115, v15, v103
    v_perm_b32 v12, v78, v74, s52
    v_perm_b32 v13, v78, v74, s53
    v_dot2c_f32_bf16 v108, v12, v99
    v_dot2c_f32_bf16 v109, v13, v99
    v_dot2c_f32_bf16 v116, v12, v103
    v_dot2c_f32_bf16 v117, v13, v103
    v_perm_b32 v14, v79, v75, s52
    v_perm_b32 v15, v79, v75, s53
    v_dot2c_f32_bf16 v110, v14, v99
    v_dot2c_f32_bf16 v111, v15, v99
    v_dot2c_f32_bf16 v118, v14, v103
    v_dot2c_f32_bf16 v119, v15, v103
    s_add_u32 s55, s55, 8192
    buffer_load_dwordx4 v[48:51], v1, s[44:47], s55 offen offset:0 nt
    buffer_load_dwordx4 v[52:55], v1, s[44:47], s55 offen offset:1024 nt
    buffer_load_dwordx4 v[56:59], v1, s[44:47], s55 offen offset:2048 nt
    buffer_load_dwordx4 v[60:63], v1, s[44:47], s55 offen offset:3072 nt
    buffer_load_dwordx4 v[64:67], v2, s[44:47], s55 offen offset:0 nt
    buffer_load_dwordx4 v[68:71], v2, s[44:47], s55 offen offset:1024 nt
    buffer_load_dwordx4 v[72:75], v2, s[44:47], s55 offen offset:2048 nt
    buffer_load_dwordx4 v[76:79], v2, s[44:47], s55 offen offset:3072 nt
    s_waitcnt vmcnt(8)
    v_dot2_f32_bf16 v80, v16, v4, 0
    v_dot2_f32_bf16 v88, v16, v8, 0
    v_dot2_f32_bf16 v81, v20, v4, 0
    v_dot2_f32_bf16 v89, v20, v8, 0
    v_dot2_f32_bf16 v82, v24, v4, 0
    v_dot2_f32_bf16 v90, v24, v8, 0
    v_dot2_f32_bf16 v83, v28, v4, 0
    v_dot2_f32_bf16 v91, v28, v8, 0
    v_dot2_f32_bf16 v84, v32, v4, 0
    v_dot2_f32_bf16 v92, v32, v8, 0
    v_dot2_f32_bf16 v85, v36, v4, 0
    v_dot2_f32_bf16 v93, v36, v8, 0
    v_dot2_f32_bf16 v86, v40, v4, 0
    v_dot2_f32_bf16 v94, v40, v8, 0
    v_dot2_f32_bf16 v87, v44, v4, 0
    v_dot2_f32_bf16 v95, v44, v8, 0
    v_dot2c_f32_bf16 v80, v17, v5
    v_dot2c_f32_bf16 v88, v17, v9
    v_dot2c_f32_bf16 v81, v21, v5
    v_dot2c_f32_bf16 v89, v21, v9
    v_dot2c_f32_bf16 v82, v25, v5
    v_dot2c_f32_bf16 v90, v25, v9
    v_dot2c_f32_bf16 v83, v29, v5
    v_dot2c_f32_bf16 v91, v29, v9
    v_dot2c_f32_bf16 v84, v33, v5
    v_dot2c_f32_bf16 v92, v33, v9
    v_dot2c_f32_bf16 v85, v37, v5
    v_dot2c_f32_bf16 v93, v37, v9
    v_dot2c_f32_bf16 v86, v41, v5
    v_dot2c_f32_bf16 v94, v41, v9
    v_dot2c_f32_bf16 v87, v45, v5
    v_dot2c_f32_bf16 v95, v45, v9
    v_dot2c_f32_bf16 v80, v18, v6
    v_dot2c_f32_bf16 v88, v18, v10
    v_dot2c_f32_bf16 v81, v22, v6
    v_dot2c_f32_bf16 v89, v22, v10
    v_dot2c_f32_bf16 v82, v26, v6
    v_dot2c_f32_bf16 v90, v26, v10
    v_dot2c_f32_bf16 v83, v30, v6
    v_dot2c_f32_bf16 v91, v30, v10
    v_dot2c_f32_bf16 v84, v34, v6
    v_dot2c_f32_bf16 v92, v34, v10
    v_dot2c_f32_bf16 v85, v38, v6
    v_dot2c_f32_bf16 v93, v38, v10
    v_dot2c_f32_bf16 v86, v42, v6
    v_dot2c_f32_bf16 v94, v42, v10
    v_dot2c_f32_bf16 v87, v46, v6
    v_dot2c_f32_bf16 v95, v46, v10
    v_dot2c_f32_bf16 v80, v19, v7
    v_dot2c_f32_bf16 v88, v19, v11
    v_dot2c_f32_bf16 v81, v23, v7
    v_dot2c_f32_bf16 v89, v23, v11
    v_dot2c_f32_bf16 v82, v27, v7
    v_dot2c_f32_bf16 v90, v27, v11
    v_dot2c_f32_bf16 v83, v31, v7
    v_dot2c_f32_bf16 v91, v31, v11
    v_dot2c_f32_bf16 v84, v35, v7
    v_dot2c_f32_bf16 v92, v35, v11
    v_dot2c_f32_bf16 v85, v39, v7
    v_dot2c_f32_bf16 v93, v39, v11
    v_dot2c_f32_bf16 v86, v43, v7
    v_dot2c_f32_bf16 v94, v43, v11
    v_dot2c_f32_bf16 v87, v47, v7
    v_dot2c_f32_bf16 v95, v47, v11
    s_add_u32 s54, s54, 8192
    buffer_load_dwordx4 v[16:19], v1, s[40:43], s54 offen offset:0 nt
    buffer_load_dwordx4 v[20:23], v1, s[40:43], s54 offen offset:1024 nt
    buffer_load_dwordx4 v[24:27], v1, s[40:43], s54 offen offset:2048 nt
    buffer_load_dwordx4 v[28:31], v1, s[40:43], s54 offen offset:3072 nt
    buffer_load_dwordx4 v[32:35], v2, s[40:43], s54 offen offset:0 nt
    buffer_load_dwordx4 v[36:39], v2, s[40:43], s54 offen offset:1024 nt
    buffer_load_dwordx4 v[40:43], v2, s[40:43], s54 offen offset:2048 nt
    buffer_load_dwordx4 v[44:47], v2, s[40:43], s54 offen offset:3072 nt
    v_add_f32_dpp v80, v80, v80 row_ror:8 row_mask:0xf bank_mask:0xf
    v_add_f32_dpp v81, v81, v81 row_ror:8 row_mask:0xf bank_mask:0xf
    v_add_f32_dpp v82, v82, v82 row_ror:8 row_mask:0xf bank_mask:0xf
    v_add_f32_dpp v83, v83, v83 row_ror:8 row_mask:0xf bank_mask:0xf
    v_add_f32_dpp v84, v84, v84 row_ror:8 row_mask:0xf bank_mask:0xf
    v_add_f32_dpp v85, v85, v85 row_ror:8 row_mask:0xf bank_mask:0xf
    v_add_f32_dpp v86, v86, v86 row_ror:8 row_mask:0xf bank_mask:0xf
    v_add_f32_dpp v87, v87, v87 row_ror:8 row_mask:0xf bank_mask:0xf
    v_add_f32_dpp v88, v88, v88 row_ror:8 row_mask:0xf bank_mask:0xf
    v_add_f32_dpp v89, v89, v89 row_ror:8 row_mask:0xf bank_mask:0xf
    v_add_f32_dpp v90, v90, v90 row_ror:8 row_mask:0xf bank_mask:0xf
    v_add_f32_dpp v91, v91, v91 row_ror:8 row_mask:0xf bank_mask:0xf
    v_add_f32_dpp v92, v92, v92 row_ror:8 row_mask:0xf bank_mask:0xf
    v_add_f32_dpp v93, v93, v93 row_ror:8 row_mask:0xf bank_mask:0xf
    v_add_f32_dpp v94, v94, v94 row_ror:8 row_mask:0xf bank_mask:0xf
    v_add_f32_dpp v95, v95, v95 row_ror:8 row_mask:0xf bank_mask:0xf
    v_add_f32_dpp v80, v80, v80 row_ror:4 row_mask:0xf bank_mask:0xf
    v_add_f32_dpp v81, v81, v81 row_ror:4 row_mask:0xf bank_mask:0xf
    v_add_f32_dpp v82, v82, v82 row_ror:4 row_mask:0xf bank_mask:0xf
    v_add_f32_dpp v83, v83, v83 row_ror:4 row_mask:0xf bank_mask:0xf
    v_add_f32_dpp v84, v84, v84 row_ror:4 row_mask:0xf bank_mask:0xf
    v_add_f32_dpp v85, v85, v85 row_ror:4 row_mask:0xf bank_mask:0xf
    v_add_f32_dpp v86, v86, v86 row_ror:4 row_mask:0xf bank_mask:0xf
    v_add_f32_dpp v87, v87, v87 row_ror:4 row_mask:0xf bank_mask:0xf
    v_add_f32_dpp v88, v88, v88 row_ror:4 row_mask:0xf bank_mask:0xf
    v_add_f32_dpp v89, v89, v89 row_ror:4 row_mask:0xf bank_mask:0xf
    v_add_f32_dpp v90, v90, v90 row_ror:4 row_mask:0xf bank_mask:0xf
    v_add_f32_dpp v91, v91, v91 row_ror:4 row_mask:0xf bank_mask:0xf
    v_add_f32_dpp v92, v92, v92 row_ror:4 row_mask:0xf bank_mask:0xf
    v_add_f32_dpp v93, v93, v93 row_ror:4 row_mask:0xf bank_mask:0xf
    v_add_f32_dpp v94, v94, v94 row_ror:4 row_mask:0xf bank_mask:0xf
    v_add_f32_dpp v95, v95, v95 row_ror:4 row_mask:0xf bank_mask:0xf
    v_add_f32_dpp v80, v80, v80 row_ror:2 row_mask:0xf bank_mask:0xf
    v_add_f32_dpp v81, v81, v81 row_ror:2 row_mask:0xf bank_mask:0xf
    v_add_f32_dpp v82, v82, v82 row_ror:2 row_mask:0xf bank_mask:0xf
    v_add_f32_dpp v83, v83, v83 row_ror:2 row_mask:0xf bank_mask:0xf
    v_add_f32_dpp v84, v84, v84 row_ror:2 row_mask:0xf bank_mask:0xf
    v_add_f32_dpp v85, v85, v85 row_ror:2 row_mask:0xf bank_mask:0xf
    v_add_f32_dpp v86, v86, v86 row_ror:2 row_mask:0xf bank_mask:0xf
    v_add_f32_dpp v87, v87, v87 row_ror:2 row_mask:0xf bank_mask:0xf
    v_add_f32_dpp v88, v88, v88 row_ror:2 row_mask:0xf bank_mask:0xf
    v_add_f32_dpp v89, v89, v89 row_ror:2 row_mask:0xf bank_mask:0xf
    v_add_f32_dpp v90, v90, v90 row_ror:2 row_mask:0xf bank_mask:0xf
    v_add_f32_dpp v91, v91, v91 row_ror:2 row_mask:0xf bank_mask:0xf
    v_add_f32_dpp v92, v92, v92 row_ror:2 row_mask:0xf bank_mask:0xf
    v_add_f32_dpp v93, v93, v93 row_ror:2 row_mask:0xf bank_mask:0xf
    v_add_f32_dpp v94, v94, v94 row_ror:2 row_mask:0xf bank_mask:0xf
    v_add_f32_dpp v95, v95, v95 row_ror:2 row_mask:0xf bank_mask:0xf
    v_add_f32_dpp v80, v80, v80 row_ror:1 row_mask:0xf bank_mask:0xf
    v_add_f32_dpp v81, v81, v81 row_ror:1 row_mask:0xf bank_mask:0xf
    v_add_f32_dpp v82, v82, v82 row_ror:1 row_mask:0xf bank_mask:0xf
    v_add_f32_dpp v83, v83, v83 row_ror:1 row_mask:0xf bank_mask:0xf
    v_add_f32_dpp v84, v84, v84 row_ror:1 row_mask:0xf bank_mask:0xf
    v_add_f32_dpp v85, v85, v85 row_ror:1 row_mask:0xf bank_mask:0xf
    v_add_f32_dpp v86, v86, v86 row_ror:1 row_mask:0xf bank_mask:0xf
    v_add_f32_dpp v87, v87, v87 row_ror:1 row_mask:0xf bank_mask:0xf
    v_add_f32_dpp v88, v88, v88 row_ror:1 row_mask:0xf bank_mask:0xf
    v_add_f32_dpp v89, v89, v89 row_ror:1 row_mask:0xf bank_mask:0xf
    v_add_f32_dpp v90, v90, v90 row_ror:1 row_mask:0xf bank_mask:0xf
    v_add_f32_dpp v91, v91, v91 row_ror:1 row_mask:0xf bank_mask:0xf
    v_add_f32_dpp v92, v92, v92 row_ror:1 row_mask:0xf bank_mask:0xf
    v_add_f32_dpp v93, v93, v93 row_ror:1 row_mask:0xf bank_mask:0xf
    v_add_f32_dpp v94, v94, v94 row_ror:1 row_mask:0xf bank_mask:0xf
    v_add_f32_dpp v95, v95, v95 row_ror:1 row_mask:0xf bank_mask:0xf
    v_max3_f32 v12, v80, v81, v82
    v_max3_f32 v12, v12, v83, v84
    v_max3_f32 v12, v12, v85, v86
    v_max3_f32 v12, v12, v87, v120
    v_sub_f32 v13, v120, v12
    v_mul_f32 v13, s56, v13
    v_exp_f32 v13, v13
    v_mul_f32 v14, s56, v12
    v_mov_b32 v120, v12
    v_fma_f32 v80, v80, s56, -v14
    v_fma_f32 v81, v81, s56, -v14
    v_fma_f32 v82, v82, s56, -v14
    v_fma_f32 v83, v83, s56, -v14
    v_fma_f32 v84, v84, s56, -v14
    v_fma_f32 v85, v85, s56, -v14
    v_fma_f32 v86, v86, s56, -v14
    v_fma_f32 v87, v87, s56, -v14
    v_exp_f32 v80, v80
    v_exp_f32 v81, v81
    v_exp_f32 v82, v82
    v_exp_f32 v83, v83
    v_exp_f32 v84, v84
    v_exp_f32 v85, v85
    v_exp_f32 v86, v86
    v_exp_f32 v87, v87
    v_mul_f32 v122, v122, v13
    v_mul_f32 v104, v104, v13
    v_mul_f32 v105, v105, v13
    v_mul_f32 v106, v106, v13
    v_mul_f32 v107, v107, v13
    v_mul_f32 v108, v108, v13
    v_mul_f32 v109, v109, v13
    v_mul_f32 v110, v110, v13
    v_mul_f32 v111, v111, v13
    v_add_f32 v122, v122, v80
    v_add_f32 v122, v122, v81
    v_add_f32 v122, v122, v82
    v_add_f32 v122, v122, v83
    v_add_f32 v122, v122, v84
    v_add_f32 v122, v122, v85
    v_add_f32 v122, v122, v86
    v_add_f32 v122, v122, v87
    v_cvt_pk_bf16_f32 v96, v80, v81
    v_cvt_pk_bf16_f32 v97, v82, v83
    v_cvt_pk_bf16_f32 v98, v84, v85
    v_cvt_pk_bf16_f32 v99, v86, v87
    v_max3_f32 v12, v88, v89, v90
    v_max3_f32 v12, v12, v91, v92
    v_max3_f32 v12, v12, v93, v94
    v_max3_f32 v12, v12, v95, v121
    v_sub_f32 v13, v121, v12
    v_mul_f32 v13, s56, v13
    v_exp_f32 v13, v13
    v_mul_f32 v14, s56, v12
    v_mov_b32 v121, v12
    v_fma_f32 v88, v88, s56, -v14
    v_fma_f32 v89, v89, s56, -v14
    v_fma_f32 v90, v90, s56, -v14
    v_fma_f32 v91, v91, s56, -v14
    v_fma_f32 v92, v92, s56, -v14
    v_fma_f32 v93, v93, s56, -v14
    v_fma_f32 v94, v94, s56, -v14
    v_fma_f32 v95, v95, s56, -v14
    v_exp_f32 v88, v88
    v_exp_f32 v89, v89
    v_exp_f32 v90, v90
    v_exp_f32 v91, v91
    v_exp_f32 v92, v92
    v_exp_f32 v93, v93
    v_exp_f32 v94, v94
    v_exp_f32 v95, v95
    v_mul_f32 v123, v123, v13
    v_mul_f32 v112, v112, v13
    v_mul_f32 v113, v113, v13
    v_mul_f32 v114, v114, v13
    v_mul_f32 v115, v115, v13
    v_mul_f32 v116, v116, v13
    v_mul_f32 v117, v117, v13
    v_mul_f32 v118, v118, v13
    v_mul_f32 v119, v119, v13
    v_add_f32 v123, v123, v88
    v_add_f32 v123, v123, v89
    v_add_f32 v123, v123, v90
    v_add_f32 v123, v123, v91
    v_add_f32 v123, v123, v92
    v_add_f32 v123, v123, v93
    v_add_f32 v123, v123, v94
    v_add_f32 v123, v123, v95
    v_cvt_pk_bf16_f32 v100, v88, v89
    v_cvt_pk_bf16_f32 v101, v90, v91
    v_cvt_pk_bf16_f32 v102, v92, v93
    v_cvt_pk_bf16_f32 v103, v94, v95
    s_waitcnt vmcnt(8)
    v_perm_b32 v12, v52, v48, s52
    v_perm_b32 v13, v52, v48, s53
    v_dot2c_f32_bf16 v104, v12, v96
    v_dot2c_f32_bf16 v105, v13, v96
    v_dot2c_f32_bf16 v112, v12, v100
    v_dot2c_f32_bf16 v113, v13, v100
    v_perm_b32 v14, v53, v49, s52
    v_perm_b32 v15, v53, v49, s53
    v_dot2c_f32_bf16 v106, v14, v96
    v_dot2c_f32_bf16 v107, v15, v96
    v_dot2c_f32_bf16 v114, v14, v100
    v_dot2c_f32_bf16 v115, v15, v100
    v_perm_b32 v12, v54, v50, s52
    v_perm_b32 v13, v54, v50, s53
    v_dot2c_f32_bf16 v108, v12, v96
    v_dot2c_f32_bf16 v109, v13, v96
    v_dot2c_f32_bf16 v116, v12, v100
    v_dot2c_f32_bf16 v117, v13, v100
    v_perm_b32 v14, v55, v51, s52
    v_perm_b32 v15, v55, v51, s53
    v_dot2c_f32_bf16 v110, v14, v96
    v_dot2c_f32_bf16 v111, v15, v96
    v_dot2c_f32_bf16 v118, v14, v100
    v_dot2c_f32_bf16 v119, v15, v100
    v_perm_b32 v12, v60, v56, s52
    v_perm_b32 v13, v60, v56, s53
    v_dot2c_f32_bf16 v104, v12, v97
    v_dot2c_f32_bf16 v105, v13, v97
    v_dot2c_f32_bf16 v112, v12, v101
    v_dot2c_f32_bf16 v113, v13, v101
    v_perm_b32 v14, v61, v57, s52
    v_perm_b32 v15, v61, v57, s53
    v_dot2c_f32_bf16 v106, v14, v97
    v_dot2c_f32_bf16 v107, v15, v97
    v_dot2c_f32_bf16 v114, v14, v101
    v_dot2c_f32_bf16 v115, v15, v101
    v_perm_b32 v12, v62, v58, s52
    v_perm_b32 v13, v62, v58, s53
    v_dot2c_f32_bf16 v108, v12, v97
    v_dot2c_f32_bf16 v109, v13, v97
    v_dot2c_f32_bf16 v116, v12, v101
    v_dot2c_f32_bf16 v117, v13, v101
    v_perm_b32 v14, v63, v59, s52
    v_perm_b32 v15, v63, v59, s53
    v_dot2c_f32_bf16 v110, v14, v97
    v_dot2c_f32_bf16 v111, v15, v97
    v_dot2c_f32_bf16 v118, v14, v101
    v_dot2c_f32_bf16 v119, v15, v101
    v_perm_b32 v12, v68, v64, s52
    v_perm_b32 v13, v68, v64, s53
    v_dot2c_f32_bf16 v104, v12, v98
    v_dot2c_f32_bf16 v105, v13, v98
    v_dot2c_f32_bf16 v112, v12, v102
    v_dot2c_f32_bf16 v113, v13, v102
    v_perm_b32 v14, v69, v65, s52
    v_perm_b32 v15, v69, v65, s53
    v_dot2c_f32_bf16 v106, v14, v98
    v_dot2c_f32_bf16 v107, v15, v98
    v_dot2c_f32_bf16 v114, v14, v102
    v_dot2c_f32_bf16 v115, v15, v102
    v_perm_b32 v12, v70, v66, s52
    v_perm_b32 v13, v70, v66, s53
    v_dot2c_f32_bf16 v108, v12, v98
    v_dot2c_f32_bf16 v109, v13, v98
    v_dot2c_f32_bf16 v116, v12, v102
    v_dot2c_f32_bf16 v117, v13, v102
    v_perm_b32 v14, v71, v67, s52
    v_perm_b32 v15, v71, v67, s53
    v_dot2c_f32_bf16 v110, v14, v98
    v_dot2c_f32_bf16 v111, v15, v98
    v_dot2c_f32_bf16 v118, v14, v102
    v_dot2c_f32_bf16 v119, v15, v102
    v_perm_b32 v12, v76, v72, s52
    v_perm_b32 v13, v76, v72, s53
    v_dot2c_f32_bf16 v104, v12, v99
    v_dot2c_f32_bf16 v105, v13, v99
    v_dot2c_f32_bf16 v112, v12, v103
    v_dot2c_f32_bf16 v113, v13, v103
    v_perm_b32 v14, v77, v73, s52
    v_perm_b32 v15, v77, v73, s53
    v_dot2c_f32_bf16 v106, v14, v99
    v_dot2c_f32_bf16 v107, v15, v99
    v_dot2c_f32_bf16 v114, v14, v103
    v_dot2c_f32_bf16 v115, v15, v103
    v_perm_b32 v12, v78, v74, s52
    v_perm_b32 v13, v78, v74, s53
    v_dot2c_f32_bf16 v108, v12, v99
    v_dot2c_f32_bf16 v109, v13, v99
    v_dot2c_f32_bf16 v116, v12, v103
    v_dot2c_f32_bf16 v117, v13, v103
    v_perm_b32 v14, v79, v75, s52
    v_perm_b32 v15, v79, v75, s53
    v_dot2c_f32_bf16 v110, v14, v99
    v_dot2c_f32_bf16 v111, v15, v99
    v_dot2c_f32_bf16 v118, v14, v103
    v_dot2c_f32_bf16 v119, v15, v103
    s_add_u32 s55, s55, 8192
    buffer_load_dwordx4 v[48:51], v1, s[44:47], s55 offen offset:0 nt
    buffer_load_dwordx4 v[52:55], v1, s[44:47], s55 offen offset:1024 nt
    buffer_load_dwordx4 v[56:59], v1, s[44:47], s55 offen offset:2048 nt
    buffer_load_dwordx4 v[60:63], v1, s[44:47], s55 offen offset:3072 nt
    buffer_load_dwordx4 v[64:67], v2, s[44:47], s55 offen offset:0 nt
    buffer_load_dwordx4 v[68:71], v2, s[44:47], s55 offen offset:1024 nt
    buffer_load_dwordx4 v[72:75], v2, s[44:47], s55 offen offset:2048 nt
    buffer_load_dwordx4 v[76:79], v2, s[44:47], s55 offen offset:3072 nt
    s_waitcnt vmcnt(8)
    v_dot2_f32_bf16 v80, v16, v4, 0
    v_dot2_f32_bf16 v88, v16, v8, 0
    v_dot2_f32_bf16 v81, v20, v4, 0
    v_dot2_f32_bf16 v89, v20, v8, 0
    v_dot2_f32_bf16 v82, v24, v4, 0
    v_dot2_f32_bf16 v90, v24, v8, 0
    v_dot2_f32_bf16 v83, v28, v4, 0
    v_dot2_f32_bf16 v91, v28, v8, 0
    v_dot2_f32_bf16 v84, v32, v4, 0
    v_dot2_f32_bf16 v92, v32, v8, 0
    v_dot2_f32_bf16 v85, v36, v4, 0
    v_dot2_f32_bf16 v93, v36, v8, 0
    v_dot2_f32_bf16 v86, v40, v4, 0
    v_dot2_f32_bf16 v94, v40, v8, 0
    v_dot2_f32_bf16 v87, v44, v4, 0
    v_dot2_f32_bf16 v95, v44, v8, 0
    v_dot2c_f32_bf16 v80, v17, v5
    v_dot2c_f32_bf16 v88, v17, v9
    v_dot2c_f32_bf16 v81, v21, v5
    v_dot2c_f32_bf16 v89, v21, v9
    v_dot2c_f32_bf16 v82, v25, v5
    v_dot2c_f32_bf16 v90, v25, v9
    v_dot2c_f32_bf16 v83, v29, v5
    v_dot2c_f32_bf16 v91, v29, v9
    v_dot2c_f32_bf16 v84, v33, v5
    v_dot2c_f32_bf16 v92, v33, v9
    v_dot2c_f32_bf16 v85, v37, v5
    v_dot2c_f32_bf16 v93, v37, v9
    v_dot2c_f32_bf16 v86, v41, v5
    v_dot2c_f32_bf16 v94, v41, v9
    v_dot2c_f32_bf16 v87, v45, v5
    v_dot2c_f32_bf16 v95, v45, v9
    v_dot2c_f32_bf16 v80, v18, v6
    v_dot2c_f32_bf16 v88, v18, v10
    v_dot2c_f32_bf16 v81, v22, v6
    v_dot2c_f32_bf16 v89, v22, v10
    v_dot2c_f32_bf16 v82, v26, v6
    v_dot2c_f32_bf16 v90, v26, v10
    v_dot2c_f32_bf16 v83, v30, v6
    v_dot2c_f32_bf16 v91, v30, v10
    v_dot2c_f32_bf16 v84, v34, v6
    v_dot2c_f32_bf16 v92, v34, v10
    v_dot2c_f32_bf16 v85, v38, v6
    v_dot2c_f32_bf16 v93, v38, v10
    v_dot2c_f32_bf16 v86, v42, v6
    v_dot2c_f32_bf16 v94, v42, v10
    v_dot2c_f32_bf16 v87, v46, v6
    v_dot2c_f32_bf16 v95, v46, v10
    v_dot2c_f32_bf16 v80, v19, v7
    v_dot2c_f32_bf16 v88, v19, v11
    v_dot2c_f32_bf16 v81, v23, v7
    v_dot2c_f32_bf16 v89, v23, v11
    v_dot2c_f32_bf16 v82, v27, v7
    v_dot2c_f32_bf16 v90, v27, v11
    v_dot2c_f32_bf16 v83, v31, v7
    v_dot2c_f32_bf16 v91, v31, v11
    v_dot2c_f32_bf16 v84, v35, v7
    v_dot2c_f32_bf16 v92, v35, v11
    v_dot2c_f32_bf16 v85, v39, v7
    v_dot2c_f32_bf16 v93, v39, v11
    v_dot2c_f32_bf16 v86, v43, v7
    v_dot2c_f32_bf16 v94, v43, v11
    v_dot2c_f32_bf16 v87, v47, v7
    v_dot2c_f32_bf16 v95, v47, v11
    s_add_u32 s54, s54, 8192
    buffer_load_dwordx4 v[16:19], v1, s[40:43], s54 offen offset:0 nt
    buffer_load_dwordx4 v[20:23], v1, s[40:43], s54 offen offset:1024 nt
    buffer_load_dwordx4 v[24:27], v1, s[40:43], s54 offen offset:2048 nt
    buffer_load_dwordx4 v[28:31], v1, s[40:43], s54 offen offset:3072 nt
    buffer_load_dwordx4 v[32:35], v2, s[40:43], s54 offen offset:0 nt
    buffer_load_dwordx4 v[36:39], v2, s[40:43], s54 offen offset:1024 nt
    buffer_load_dwordx4 v[40:43], v2, s[40:43], s54 offen offset:2048 nt
    buffer_load_dwordx4 v[44:47], v2, s[40:43], s54 offen offset:3072 nt
    v_add_f32_dpp v80, v80, v80 row_ror:8 row_mask:0xf bank_mask:0xf
    v_add_f32_dpp v81, v81, v81 row_ror:8 row_mask:0xf bank_mask:0xf
    v_add_f32_dpp v82, v82, v82 row_ror:8 row_mask:0xf bank_mask:0xf
    v_add_f32_dpp v83, v83, v83 row_ror:8 row_mask:0xf bank_mask:0xf
    v_add_f32_dpp v84, v84, v84 row_ror:8 row_mask:0xf bank_mask:0xf
    v_add_f32_dpp v85, v85, v85 row_ror:8 row_mask:0xf bank_mask:0xf
    v_add_f32_dpp v86, v86, v86 row_ror:8 row_mask:0xf bank_mask:0xf
    v_add_f32_dpp v87, v87, v87 row_ror:8 row_mask:0xf bank_mask:0xf
    v_add_f32_dpp v88, v88, v88 row_ror:8 row_mask:0xf bank_mask:0xf
    v_add_f32_dpp v89, v89, v89 row_ror:8 row_mask:0xf bank_mask:0xf
    v_add_f32_dpp v90, v90, v90 row_ror:8 row_mask:0xf bank_mask:0xf
    v_add_f32_dpp v91, v91, v91 row_ror:8 row_mask:0xf bank_mask:0xf
    v_add_f32_dpp v92, v92, v92 row_ror:8 row_mask:0xf bank_mask:0xf
    v_add_f32_dpp v93, v93, v93 row_ror:8 row_mask:0xf bank_mask:0xf
    v_add_f32_dpp v94, v94, v94 row_ror:8 row_mask:0xf bank_mask:0xf
    v_add_f32_dpp v95, v95, v95 row_ror:8 row_mask:0xf bank_mask:0xf
    v_add_f32_dpp v80, v80, v80 row_ror:4 row_mask:0xf bank_mask:0xf
    v_add_f32_dpp v81, v81, v81 row_ror:4 row_mask:0xf bank_mask:0xf
    v_add_f32_dpp v82, v82, v82 row_ror:4 row_mask:0xf bank_mask:0xf
    v_add_f32_dpp v83, v83, v83 row_ror:4 row_mask:0xf bank_mask:0xf
    v_add_f32_dpp v84, v84, v84 row_ror:4 row_mask:0xf bank_mask:0xf
    v_add_f32_dpp v85, v85, v85 row_ror:4 row_mask:0xf bank_mask:0xf
    v_add_f32_dpp v86, v86, v86 row_ror:4 row_mask:0xf bank_mask:0xf
    v_add_f32_dpp v87, v87, v87 row_ror:4 row_mask:0xf bank_mask:0xf
    v_add_f32_dpp v88, v88, v88 row_ror:4 row_mask:0xf bank_mask:0xf
    v_add_f32_dpp v89, v89, v89 row_ror:4 row_mask:0xf bank_mask:0xf
    v_add_f32_dpp v90, v90, v90 row_ror:4 row_mask:0xf bank_mask:0xf
    v_add_f32_dpp v91, v91, v91 row_ror:4 row_mask:0xf bank_mask:0xf
    v_add_f32_dpp v92, v92, v92 row_ror:4 row_mask:0xf bank_mask:0xf
    v_add_f32_dpp v93, v93, v93 row_ror:4 row_mask:0xf bank_mask:0xf
    v_add_f32_dpp v94, v94, v94 row_ror:4 row_mask:0xf bank_mask:0xf
    v_add_f32_dpp v95, v95, v95 row_ror:4 row_mask:0xf bank_mask:0xf
    v_add_f32_dpp v80, v80, v80 row_ror:2 row_mask:0xf bank_mask:0xf
    v_add_f32_dpp v81, v81, v81 row_ror:2 row_mask:0xf bank_mask:0xf
    v_add_f32_dpp v82, v82, v82 row_ror:2 row_mask:0xf bank_mask:0xf
    v_add_f32_dpp v83, v83, v83 row_ror:2 row_mask:0xf bank_mask:0xf
    v_add_f32_dpp v84, v84, v84 row_ror:2 row_mask:0xf bank_mask:0xf
    v_add_f32_dpp v85, v85, v85 row_ror:2 row_mask:0xf bank_mask:0xf
    v_add_f32_dpp v86, v86, v86 row_ror:2 row_mask:0xf bank_mask:0xf
    v_add_f32_dpp v87, v87, v87 row_ror:2 row_mask:0xf bank_mask:0xf
    v_add_f32_dpp v88, v88, v88 row_ror:2 row_mask:0xf bank_mask:0xf
    v_add_f32_dpp v89, v89, v89 row_ror:2 row_mask:0xf bank_mask:0xf
    v_add_f32_dpp v90, v90, v90 row_ror:2 row_mask:0xf bank_mask:0xf
    v_add_f32_dpp v91, v91, v91 row_ror:2 row_mask:0xf bank_mask:0xf
    v_add_f32_dpp v92, v92, v92 row_ror:2 row_mask:0xf bank_mask:0xf
    v_add_f32_dpp v93, v93, v93 row_ror:2 row_mask:0xf bank_mask:0xf
    v_add_f32_dpp v94, v94, v94 row_ror:2 row_mask:0xf bank_mask:0xf
    v_add_f32_dpp v95, v95, v95 row_ror:2 row_mask:0xf bank_mask:0xf
    v_add_f32_dpp v80, v80, v80 row_ror:1 row_mask:0xf bank_mask:0xf
    v_add_f32_dpp v81, v81, v81 row_ror:1 row_mask:0xf bank_mask:0xf
    v_add_f32_dpp v82, v82, v82 row_ror:1 row_mask:0xf bank_mask:0xf
    v_add_f32_dpp v83, v83, v83 row_ror:1 row_mask:0xf bank_mask:0xf
    v_add_f32_dpp v84, v84, v84 row_ror:1 row_mask:0xf bank_mask:0xf
    v_add_f32_dpp v85, v85, v85 row_ror:1 row_mask:0xf bank_mask:0xf
    v_add_f32_dpp v86, v86, v86 row_ror:1 row_mask:0xf bank_mask:0xf
    v_add_f32_dpp v87, v87, v87 row_ror:1 row_mask:0xf bank_mask:0xf
    v_add_f32_dpp v88, v88, v88 row_ror:1 row_mask:0xf bank_mask:0xf
    v_add_f32_dpp v89, v89, v89 row_ror:1 row_mask:0xf bank_mask:0xf
    v_add_f32_dpp v90, v90, v90 row_ror:1 row_mask:0xf bank_mask:0xf
    v_add_f32_dpp v91, v91, v91 row_ror:1 row_mask:0xf bank_mask:0xf
    v_add_f32_dpp v92, v92, v92 row_ror:1 row_mask:0xf bank_mask:0xf
    v_add_f32_dpp v93, v93, v93 row_ror:1 row_mask:0xf bank_mask:0xf
    v_add_f32_dpp v94, v94, v94 row_ror:1 row_mask:0xf bank_mask:0xf
    v_add_f32_dpp v95, v95, v95 row_ror:1 row_mask:0xf bank_mask:0xf
    v_max3_f32 v12, v80, v81, v82
    v_max3_f32 v12, v12, v83, v84
    v_max3_f32 v12, v12, v85, v86
    v_max3_f32 v12, v12, v87, v120
    v_sub_f32 v13, v120, v12
    v_mul_f32 v13, s56, v13
    v_exp_f32 v13, v13
    v_mul_f32 v14, s56, v12
    v_mov_b32 v120, v12
    v_fma_f32 v80, v80, s56, -v14
    v_fma_f32 v81, v81, s56, -v14
    v_fma_f32 v82, v82, s56, -v14
    v_fma_f32 v83, v83, s56, -v14
    v_fma_f32 v84, v84, s56, -v14
    v_fma_f32 v85, v85, s56, -v14
    v_fma_f32 v86, v86, s56, -v14
    v_fma_f32 v87, v87, s56, -v14
    v_exp_f32 v80, v80
    v_exp_f32 v81, v81
    v_exp_f32 v82, v82
    v_exp_f32 v83, v83
    v_exp_f32 v84, v84
    v_exp_f32 v85, v85
    v_exp_f32 v86, v86
    v_exp_f32 v87, v87
    v_mul_f32 v122, v122, v13
    v_mul_f32 v104, v104, v13
    v_mul_f32 v105, v105, v13
    v_mul_f32 v106, v106, v13
    v_mul_f32 v107, v107, v13
    v_mul_f32 v108, v108, v13
    v_mul_f32 v109, v109, v13
    v_mul_f32 v110, v110, v13
    v_mul_f32 v111, v111, v13
    v_add_f32 v122, v122, v80
    v_add_f32 v122, v122, v81
    v_add_f32 v122, v122, v82
    v_add_f32 v122, v122, v83
    v_add_f32 v122, v122, v84
    v_add_f32 v122, v122, v85
    v_add_f32 v122, v122, v86
    v_add_f32 v122, v122, v87
    v_cvt_pk_bf16_f32 v96, v80, v81
    v_cvt_pk_bf16_f32 v97, v82, v83
    v_cvt_pk_bf16_f32 v98, v84, v85
    v_cvt_pk_bf16_f32 v99, v86, v87
    v_max3_f32 v12, v88, v89, v90
    v_max3_f32 v12, v12, v91, v92
    v_max3_f32 v12, v12, v93, v94
    v_max3_f32 v12, v12, v95, v121
    v_sub_f32 v13, v121, v12
    v_mul_f32 v13, s56, v13
    v_exp_f32 v13, v13
    v_mul_f32 v14, s56, v12
    v_mov_b32 v121, v12
    v_fma_f32 v88, v88, s56, -v14
    v_fma_f32 v89, v89, s56, -v14
    v_fma_f32 v90, v90, s56, -v14
    v_fma_f32 v91, v91, s56, -v14
    v_fma_f32 v92, v92, s56, -v14
    v_fma_f32 v93, v93, s56, -v14
    v_fma_f32 v94, v94, s56, -v14
    v_fma_f32 v95, v95, s56, -v14
    v_exp_f32 v88, v88
    v_exp_f32 v89, v89
    v_exp_f32 v90, v90
    v_exp_f32 v91, v91
    v_exp_f32 v92, v92
    v_exp_f32 v93, v93
    v_exp_f32 v94, v94
    v_exp_f32 v95, v95
    v_mul_f32 v123, v123, v13
    v_mul_f32 v112, v112, v13
    v_mul_f32 v113, v113, v13
    v_mul_f32 v114, v114, v13
    v_mul_f32 v115, v115, v13
    v_mul_f32 v116, v116, v13
    v_mul_f32 v117, v117, v13
    v_mul_f32 v118, v118, v13
    v_mul_f32 v119, v119, v13
    v_add_f32 v123, v123, v88
    v_add_f32 v123, v123, v89
    v_add_f32 v123, v123, v90
    v_add_f32 v123, v123, v91
    v_add_f32 v123, v123, v92
    v_add_f32 v123, v123, v93
    v_add_f32 v123, v123, v94
    v_add_f32 v123, v123, v95
    v_cvt_pk_bf16_f32 v100, v88, v89
    v_cvt_pk_bf16_f32 v101, v90, v91
    v_cvt_pk_bf16_f32 v102, v92, v93
    v_cvt_pk_bf16_f32 v103, v94, v95
    s_waitcnt vmcnt(8)
    v_perm_b32 v12, v52, v48, s52
    v_perm_b32 v13, v52, v48, s53
    v_dot2c_f32_bf16 v104, v12, v96
    v_dot2c_f32_bf16 v105, v13, v96
    v_dot2c_f32_bf16 v112, v12, v100
    v_dot2c_f32_bf16 v113, v13, v100
    v_perm_b32 v14, v53, v49, s52
    v_perm_b32 v15, v53, v49, s53
    v_dot2c_f32_bf16 v106, v14, v96
    v_dot2c_f32_bf16 v107, v15, v96
    v_dot2c_f32_bf16 v114, v14, v100
    v_dot2c_f32_bf16 v115, v15, v100
    v_perm_b32 v12, v54, v50, s52
    v_perm_b32 v13, v54, v50, s53
    v_dot2c_f32_bf16 v108, v12, v96
    v_dot2c_f32_bf16 v109, v13, v96
    v_dot2c_f32_bf16 v116, v12, v100
    v_dot2c_f32_bf16 v117, v13, v100
    v_perm_b32 v14, v55, v51, s52
    v_perm_b32 v15, v55, v51, s53
    v_dot2c_f32_bf16 v110, v14, v96
    v_dot2c_f32_bf16 v111, v15, v96
    v_dot2c_f32_bf16 v118, v14, v100
    v_dot2c_f32_bf16 v119, v15, v100
    v_perm_b32 v12, v60, v56, s52
    v_perm_b32 v13, v60, v56, s53
    v_dot2c_f32_bf16 v104, v12, v97
    v_dot2c_f32_bf16 v105, v13, v97
    v_dot2c_f32_bf16 v112, v12, v101
    v_dot2c_f32_bf16 v113, v13, v101
    v_perm_b32 v14, v61, v57, s52
    v_perm_b32 v15, v61, v57, s53
    v_dot2c_f32_bf16 v106, v14, v97
    v_dot2c_f32_bf16 v107, v15, v97
    v_dot2c_f32_bf16 v114, v14, v101
    v_dot2c_f32_bf16 v115, v15, v101
    v_perm_b32 v12, v62, v58, s52
    v_perm_b32 v13, v62, v58, s53
    v_dot2c_f32_bf16 v108, v12, v97
    v_dot2c_f32_bf16 v109, v13, v97
    v_dot2c_f32_bf16 v116, v12, v101
    v_dot2c_f32_bf16 v117, v13, v101
    v_perm_b32 v14, v63, v59, s52
    v_perm_b32 v15, v63, v59, s53
    v_dot2c_f32_bf16 v110, v14, v97
    v_dot2c_f32_bf16 v111, v15, v97
    v_dot2c_f32_bf16 v118, v14, v101
    v_dot2c_f32_bf16 v119, v15, v101
    v_perm_b32 v12, v68, v64, s52
    v_perm_b32 v13, v68, v64, s53
    v_dot2c_f32_bf16 v104, v12, v98
    v_dot2c_f32_bf16 v105, v13, v98
    v_dot2c_f32_bf16 v112, v12, v102
    v_dot2c_f32_bf16 v113, v13, v102
    v_perm_b32 v14, v69, v65, s52
    v_perm_b32 v15, v69, v65, s53
    v_dot2c_f32_bf16 v106, v14, v98
    v_dot2c_f32_bf16 v107, v15, v98
    v_dot2c_f32_bf16 v114, v14, v102
    v_dot2c_f32_bf16 v115, v15, v102
    v_perm_b32 v12, v70, v66, s52
    v_perm_b32 v13, v70, v66, s53
    v_dot2c_f32_bf16 v108, v12, v98
    v_dot2c_f32_bf16 v109, v13, v98
    v_dot2c_f32_bf16 v116, v12, v102
    v_dot2c_f32_bf16 v117, v13, v102
    v_perm_b32 v14, v71, v67, s52
    v_perm_b32 v15, v71, v67, s53
    v_dot2c_f32_bf16 v110, v14, v98
    v_dot2c_f32_bf16 v111, v15, v98
    v_dot2c_f32_bf16 v118, v14, v102
    v_dot2c_f32_bf16 v119, v15, v102
    v_perm_b32 v12, v76, v72, s52
    v_perm_b32 v13, v76, v72, s53
    v_dot2c_f32_bf16 v104, v12, v99
    v_dot2c_f32_bf16 v105, v13, v99
    v_dot2c_f32_bf16 v112, v12, v103
    v_dot2c_f32_bf16 v113, v13, v103
    v_perm_b32 v14, v77, v73, s52
    v_perm_b32 v15, v77, v73, s53
    v_dot2c_f32_bf16 v106, v14, v99
    v_dot2c_f32_bf16 v107, v15, v99
    v_dot2c_f32_bf16 v114, v14, v103
    v_dot2c_f32_bf16 v115, v15, v103
    v_perm_b32 v12, v78, v74, s52
    v_perm_b32 v13, v78, v74, s53
    v_dot2c_f32_bf16 v108, v12, v99
    v_dot2c_f32_bf16 v109, v13, v99
    v_dot2c_f32_bf16 v116, v12, v103
    v_dot2c_f32_bf16 v117, v13, v103
    v_perm_b32 v14, v79, v75, s52
    v_perm_b32 v15, v79, v75, s53
    v_dot2c_f32_bf16 v110, v14, v99
    v_dot2c_f32_bf16 v111, v15, v99
    v_dot2c_f32_bf16 v118, v14, v103
    v_dot2c_f32_bf16 v119, v15, v103
    s_add_u32 s55, s55, 8192
    buffer_load_dwordx4 v[48:51], v1, s[44:47], s55 offen offset:0 nt
    buffer_load_dwordx4 v[52:55], v1, s[44:47], s55 offen offset:1024 nt
    buffer_load_dwordx4 v[56:59], v1, s[44:47], s55 offen offset:2048 nt
    buffer_load_dwordx4 v[60:63], v1, s[44:47], s55 offen offset:3072 nt
    buffer_load_dwordx4 v[64:67], v2, s[44:47], s55 offen offset:0 nt
    buffer_load_dwordx4 v[68:71], v2, s[44:47], s55 offen offset:1024 nt
    buffer_load_dwordx4 v[72:75], v2, s[44:47], s55 offen offset:2048 nt
    buffer_load_dwordx4 v[76:79], v2, s[44:47], s55 offen offset:3072 nt
    s_waitcnt vmcnt(8)
    v_dot2_f32_bf16 v80, v16, v4, 0
    v_dot2_f32_bf16 v88, v16, v8, 0
    v_dot2_f32_bf16 v81, v20, v4, 0
    v_dot2_f32_bf16 v89, v20, v8, 0
    v_dot2_f32_bf16 v82, v24, v4, 0
    v_dot2_f32_bf16 v90, v24, v8, 0
    v_dot2_f32_bf16 v83, v28, v4, 0
    v_dot2_f32_bf16 v91, v28, v8, 0
    v_dot2_f32_bf16 v84, v32, v4, 0
    v_dot2_f32_bf16 v92, v32, v8, 0
    v_dot2_f32_bf16 v85, v36, v4, 0
    v_dot2_f32_bf16 v93, v36, v8, 0
    v_dot2_f32_bf16 v86, v40, v4, 0
    v_dot2_f32_bf16 v94, v40, v8, 0
    v_dot2_f32_bf16 v87, v44, v4, 0
    v_dot2_f32_bf16 v95, v44, v8, 0
    v_dot2c_f32_bf16 v80, v17, v5
    v_dot2c_f32_bf16 v88, v17, v9
    v_dot2c_f32_bf16 v81, v21, v5
    v_dot2c_f32_bf16 v89, v21, v9
    v_dot2c_f32_bf16 v82, v25, v5
    v_dot2c_f32_bf16 v90, v25, v9
    v_dot2c_f32_bf16 v83, v29, v5
    v_dot2c_f32_bf16 v91, v29, v9
    v_dot2c_f32_bf16 v84, v33, v5
    v_dot2c_f32_bf16 v92, v33, v9
    v_dot2c_f32_bf16 v85, v37, v5
    v_dot2c_f32_bf16 v93, v37, v9
    v_dot2c_f32_bf16 v86, v41, v5
    v_dot2c_f32_bf16 v94, v41, v9
    v_dot2c_f32_bf16 v87, v45, v5
    v_dot2c_f32_bf16 v95, v45, v9
    v_dot2c_f32_bf16 v80, v18, v6
    v_dot2c_f32_bf16 v88, v18, v10
    v_dot2c_f32_bf16 v81, v22, v6
    v_dot2c_f32_bf16 v89, v22, v10
    v_dot2c_f32_bf16 v82, v26, v6
    v_dot2c_f32_bf16 v90, v26, v10
    v_dot2c_f32_bf16 v83, v30, v6
    v_dot2c_f32_bf16 v91, v30, v10
    v_dot2c_f32_bf16 v84, v34, v6
    v_dot2c_f32_bf16 v92, v34, v10
    v_dot2c_f32_bf16 v85, v38, v6
    v_dot2c_f32_bf16 v93, v38, v10
    v_dot2c_f32_bf16 v86, v42, v6
    v_dot2c_f32_bf16 v94, v42, v10
    v_dot2c_f32_bf16 v87, v46, v6
    v_dot2c_f32_bf16 v95, v46, v10
    v_dot2c_f32_bf16 v80, v19, v7
    v_dot2c_f32_bf16 v88, v19, v11
    v_dot2c_f32_bf16 v81, v23, v7
    v_dot2c_f32_bf16 v89, v23, v11
    v_dot2c_f32_bf16 v82, v27, v7
    v_dot2c_f32_bf16 v90, v27, v11
    v_dot2c_f32_bf16 v83, v31, v7
    v_dot2c_f32_bf16 v91, v31, v11
    v_dot2c_f32_bf16 v84, v35, v7
    v_dot2c_f32_bf16 v92, v35, v11
    v_dot2c_f32_bf16 v85, v39, v7
    v_dot2c_f32_bf16 v93, v39, v11
    v_dot2c_f32_bf16 v86, v43, v7
    v_dot2c_f32_bf16 v94, v43, v11
    v_dot2c_f32_bf16 v87, v47, v7
    v_dot2c_f32_bf16 v95, v47, v11
    s_add_u32 s54, s54, 8192
    buffer_load_dwordx4 v[16:19], v1, s[40:43], s54 offen offset:0 nt
    buffer_load_dwordx4 v[20:23], v1, s[40:43], s54 offen offset:1024 nt
    buffer_load_dwordx4 v[24:27], v1, s[40:43], s54 offen offset:2048 nt
    buffer_load_dwordx4 v[28:31], v1, s[40:43], s54 offen offset:3072 nt
    buffer_load_dwordx4 v[32:35], v2, s[40:43], s54 offen offset:0 nt
    buffer_load_dwordx4 v[36:39], v2, s[40:43], s54 offen offset:1024 nt
    buffer_load_dwordx4 v[40:43], v2, s[40:43], s54 offen offset:2048 nt
    buffer_load_dwordx4 v[44:47], v2, s[40:43], s54 offen offset:3072 nt
    v_add_f32_dpp v80, v80, v80 row_ror:8 row_mask:0xf bank_mask:0xf
    v_add_f32_dpp v81, v81, v81 row_ror:8 row_mask:0xf bank_mask:0xf
    v_add_f32_dpp v82, v82, v82 row_ror:8 row_mask:0xf bank_mask:0xf
    v_add_f32_dpp v83, v83, v83 row_ror:8 row_mask:0xf bank_mask:0xf
    v_add_f32_dpp v84, v84, v84 row_ror:8 row_mask:0xf bank_mask:0xf
    v_add_f32_dpp v85, v85, v85 row_ror:8 row_mask:0xf bank_mask:0xf
    v_add_f32_dpp v86, v86, v86 row_ror:8 row_mask:0xf bank_mask:0xf
    v_add_f32_dpp v87, v87, v87 row_ror:8 row_mask:0xf bank_mask:0xf
    v_add_f32_dpp v88, v88, v88 row_ror:8 row_mask:0xf bank_mask:0xf
    v_add_f32_dpp v89, v89, v89 row_ror:8 row_mask:0xf bank_mask:0xf
    v_add_f32_dpp v90, v90, v90 row_ror:8 row_mask:0xf bank_mask:0xf
    v_add_f32_dpp v91, v91, v91 row_ror:8 row_mask:0xf bank_mask:0xf
    v_add_f32_dpp v92, v92, v92 row_ror:8 row_mask:0xf bank_mask:0xf
    v_add_f32_dpp v93, v93, v93 row_ror:8 row_mask:0xf bank_mask:0xf
    v_add_f32_dpp v94, v94, v94 row_ror:8 row_mask:0xf bank_mask:0xf
    v_add_f32_dpp v95, v95, v95 row_ror:8 row_mask:0xf bank_mask:0xf
    v_add_f32_dpp v80, v80, v80 row_ror:4 row_mask:0xf bank_mask:0xf
    v_add_f32_dpp v81, v81, v81 row_ror:4 row_mask:0xf bank_mask:0xf
    v_add_f32_dpp v82, v82, v82 row_ror:4 row_mask:0xf bank_mask:0xf
    v_add_f32_dpp v83, v83, v83 row_ror:4 row_mask:0xf bank_mask:0xf
    v_add_f32_dpp v84, v84, v84 row_ror:4 row_mask:0xf bank_mask:0xf
    v_add_f32_dpp v85, v85, v85 row_ror:4 row_mask:0xf bank_mask:0xf
    v_add_f32_dpp v86, v86, v86 row_ror:4 row_mask:0xf bank_mask:0xf
    v_add_f32_dpp v87, v87, v87 row_ror:4 row_mask:0xf bank_mask:0xf
    v_add_f32_dpp v88, v88, v88 row_ror:4 row_mask:0xf bank_mask:0xf
    v_add_f32_dpp v89, v89, v89 row_ror:4 row_mask:0xf bank_mask:0xf
    v_add_f32_dpp v90, v90, v90 row_ror:4 row_mask:0xf bank_mask:0xf
    v_add_f32_dpp v91, v91, v91 row_ror:4 row_mask:0xf bank_mask:0xf
    v_add_f32_dpp v92, v92, v92 row_ror:4 row_mask:0xf bank_mask:0xf
    v_add_f32_dpp v93, v93, v93 row_ror:4 row_mask:0xf bank_mask:0xf
    v_add_f32_dpp v94, v94, v94 row_ror:4 row_mask:0xf bank_mask:0xf
    v_add_f32_dpp v95, v95, v95 row_ror:4 row_mask:0xf bank_mask:0xf
    v_add_f32_dpp v80, v80, v80 row_ror:2 row_mask:0xf bank_mask:0xf
    v_add_f32_dpp v81, v81, v81 row_ror:2 row_mask:0xf bank_mask:0xf
    v_add_f32_dpp v82, v82, v82 row_ror:2 row_mask:0xf bank_mask:0xf
    v_add_f32_dpp v83, v83, v83 row_ror:2 row_mask:0xf bank_mask:0xf
    v_add_f32_dpp v84, v84, v84 row_ror:2 row_mask:0xf bank_mask:0xf
    v_add_f32_dpp v85, v85, v85 row_ror:2 row_mask:0xf bank_mask:0xf
    v_add_f32_dpp v86, v86, v86 row_ror:2 row_mask:0xf bank_mask:0xf
    v_add_f32_dpp v87, v87, v87 row_ror:2 row_mask:0xf bank_mask:0xf
    v_add_f32_dpp v88, v88, v88 row_ror:2 row_mask:0xf bank_mask:0xf
    v_add_f32_dpp v89, v89, v89 row_ror:2 row_mask:0xf bank_mask:0xf
    v_add_f32_dpp v90, v90, v90 row_ror:2 row_mask:0xf bank_mask:0xf
    v_add_f32_dpp v91, v91, v91 row_ror:2 row_mask:0xf bank_mask:0xf
    v_add_f32_dpp v92, v92, v92 row_ror:2 row_mask:0xf bank_mask:0xf
    v_add_f32_dpp v93, v93, v93 row_ror:2 row_mask:0xf bank_mask:0xf
    v_add_f32_dpp v94, v94, v94 row_ror:2 row_mask:0xf bank_mask:0xf
    v_add_f32_dpp v95, v95, v95 row_ror:2 row_mask:0xf bank_mask:0xf
    v_add_f32_dpp v80, v80, v80 row_ror:1 row_mask:0xf bank_mask:0xf
    v_add_f32_dpp v81, v81, v81 row_ror:1 row_mask:0xf bank_mask:0xf
    v_add_f32_dpp v82, v82, v82 row_ror:1 row_mask:0xf bank_mask:0xf
    v_add_f32_dpp v83, v83, v83 row_ror:1 row_mask:0xf bank_mask:0xf
    v_add_f32_dpp v84, v84, v84 row_ror:1 row_mask:0xf bank_mask:0xf
    v_add_f32_dpp v85, v85, v85 row_ror:1 row_mask:0xf bank_mask:0xf
    v_add_f32_dpp v86, v86, v86 row_ror:1 row_mask:0xf bank_mask:0xf
    v_add_f32_dpp v87, v87, v87 row_ror:1 row_mask:0xf bank_mask:0xf
    v_add_f32_dpp v88, v88, v88 row_ror:1 row_mask:0xf bank_mask:0xf
    v_add_f32_dpp v89, v89, v89 row_ror:1 row_mask:0xf bank_mask:0xf
    v_add_f32_dpp v90, v90, v90 row_ror:1 row_mask:0xf bank_mask:0xf
    v_add_f32_dpp v91, v91, v91 row_ror:1 row_mask:0xf bank_mask:0xf
    v_add_f32_dpp v92, v92, v92 row_ror:1 row_mask:0xf bank_mask:0xf
    v_add_f32_dpp v93, v93, v93 row_ror:1 row_mask:0xf bank_mask:0xf
    v_add_f32_dpp v94, v94, v94 row_ror:1 row_mask:0xf bank_mask:0xf
    v_add_f32_dpp v95, v95, v95 row_ror:1 row_mask:0xf bank_mask:0xf
    v_max3_f32 v12, v80, v81, v82
    v_max3_f32 v12, v12, v83, v84
    v_max3_f32 v12, v12, v85, v86
    v_max3_f32 v12, v12, v87, v120
    v_sub_f32 v13, v120, v12
    v_mul_f32 v13, s56, v13
    v_exp_f32 v13, v13
    v_mul_f32 v14, s56, v12
    v_mov_b32 v120, v12
    v_fma_f32 v80, v80, s56, -v14
    v_fma_f32 v81, v81, s56, -v14
    v_fma_f32 v82, v82, s56, -v14
    v_fma_f32 v83, v83, s56, -v14
    v_fma_f32 v84, v84, s56, -v14
    v_fma_f32 v85, v85, s56, -v14
    v_fma_f32 v86, v86, s56, -v14
    v_fma_f32 v87, v87, s56, -v14
    v_exp_f32 v80, v80
    v_exp_f32 v81, v81
    v_exp_f32 v82, v82
    v_exp_f32 v83, v83
    v_exp_f32 v84, v84
    v_exp_f32 v85, v85
    v_exp_f32 v86, v86
    v_exp_f32 v87, v87
    v_mul_f32 v122, v122, v13
    v_mul_f32 v104, v104, v13
    v_mul_f32 v105, v105, v13
    v_mul_f32 v106, v106, v13
    v_mul_f32 v107, v107, v13
    v_mul_f32 v108, v108, v13
    v_mul_f32 v109, v109, v13
    v_mul_f32 v110, v110, v13
    v_mul_f32 v111, v111, v13
    v_add_f32 v122, v122, v80
    v_add_f32 v122, v122, v81
    v_add_f32 v122, v122, v82
    v_add_f32 v122, v122, v83
    v_add_f32 v122, v122, v84
    v_add_f32 v122, v122, v85
    v_add_f32 v122, v122, v86
    v_add_f32 v122, v122, v87
    v_cvt_pk_bf16_f32 v96, v80, v81
    v_cvt_pk_bf16_f32 v97, v82, v83
    v_cvt_pk_bf16_f32 v98, v84, v85
    v_cvt_pk_bf16_f32 v99, v86, v87
    v_max3_f32 v12, v88, v89, v90
    v_max3_f32 v12, v12, v91, v92
    v_max3_f32 v12, v12, v93, v94
    v_max3_f32 v12, v12, v95, v121
    v_sub_f32 v13, v121, v12
    v_mul_f32 v13, s56, v13
    v_exp_f32 v13, v13
    v_mul_f32 v14, s56, v12
    v_mov_b32 v121, v12
    v_fma_f32 v88, v88, s56, -v14
    v_fma_f32 v89, v89, s56, -v14
    v_fma_f32 v90, v90, s56, -v14
    v_fma_f32 v91, v91, s56, -v14
    v_fma_f32 v92, v92, s56, -v14
    v_fma_f32 v93, v93, s56, -v14
    v_fma_f32 v94, v94, s56, -v14
    v_fma_f32 v95, v95, s56, -v14
    v_exp_f32 v88, v88
    v_exp_f32 v89, v89
    v_exp_f32 v90, v90
    v_exp_f32 v91, v91
    v_exp_f32 v92, v92
    v_exp_f32 v93, v93
    v_exp_f32 v94, v94
    v_exp_f32 v95, v95
    v_mul_f32 v123, v123, v13
    v_mul_f32 v112, v112, v13
    v_mul_f32 v113, v113, v13
    v_mul_f32 v114, v114, v13
    v_mul_f32 v115, v115, v13
    v_mul_f32 v116, v116, v13
    v_mul_f32 v117, v117, v13
    v_mul_f32 v118, v118, v13
    v_mul_f32 v119, v119, v13
    v_add_f32 v123, v123, v88
    v_add_f32 v123, v123, v89
    v_add_f32 v123, v123, v90
    v_add_f32 v123, v123, v91
    v_add_f32 v123, v123, v92
    v_add_f32 v123, v123, v93
    v_add_f32 v123, v123, v94
    v_add_f32 v123, v123, v95
    v_cvt_pk_bf16_f32 v100, v88, v89
    v_cvt_pk_bf16_f32 v101, v90, v91
    v_cvt_pk_bf16_f32 v102, v92, v93
    v_cvt_pk_bf16_f32 v103, v94, v95
    s_waitcnt vmcnt(8)
    v_perm_b32 v12, v52, v48, s52
    v_perm_b32 v13, v52, v48, s53
    v_dot2c_f32_bf16 v104, v12, v96
    v_dot2c_f32_bf16 v105, v13, v96
    v_dot2c_f32_bf16 v112, v12, v100
    v_dot2c_f32_bf16 v113, v13, v100
    v_perm_b32 v14, v53, v49, s52
    v_perm_b32 v15, v53, v49, s53
    v_dot2c_f32_bf16 v106, v14, v96
    v_dot2c_f32_bf16 v107, v15, v96
    v_dot2c_f32_bf16 v114, v14, v100
    v_dot2c_f32_bf16 v115, v15, v100
    v_perm_b32 v12, v54, v50, s52
    v_perm_b32 v13, v54, v50, s53
    v_dot2c_f32_bf16 v108, v12, v96
    v_dot2c_f32_bf16 v109, v13, v96
    v_dot2c_f32_bf16 v116, v12, v100
    v_dot2c_f32_bf16 v117, v13, v100
    v_perm_b32 v14, v55, v51, s52
    v_perm_b32 v15, v55, v51, s53
    v_dot2c_f32_bf16 v110, v14, v96
    v_dot2c_f32_bf16 v111, v15, v96
    v_dot2c_f32_bf16 v118, v14, v100
    v_dot2c_f32_bf16 v119, v15, v100
    v_perm_b32 v12, v60, v56, s52
    v_perm_b32 v13, v60, v56, s53
    v_dot2c_f32_bf16 v104, v12, v97
    v_dot2c_f32_bf16 v105, v13, v97
    v_dot2c_f32_bf16 v112, v12, v101
    v_dot2c_f32_bf16 v113, v13, v101
    v_perm_b32 v14, v61, v57, s52
    v_perm_b32 v15, v61, v57, s53
    v_dot2c_f32_bf16 v106, v14, v97
    v_dot2c_f32_bf16 v107, v15, v97
    v_dot2c_f32_bf16 v114, v14, v101
    v_dot2c_f32_bf16 v115, v15, v101
    v_perm_b32 v12, v62, v58, s52
    v_perm_b32 v13, v62, v58, s53
    v_dot2c_f32_bf16 v108, v12, v97
    v_dot2c_f32_bf16 v109, v13, v97
    v_dot2c_f32_bf16 v116, v12, v101
    v_dot2c_f32_bf16 v117, v13, v101
    v_perm_b32 v14, v63, v59, s52
    v_perm_b32 v15, v63, v59, s53
    v_dot2c_f32_bf16 v110, v14, v97
    v_dot2c_f32_bf16 v111, v15, v97
    v_dot2c_f32_bf16 v118, v14, v101
    v_dot2c_f32_bf16 v119, v15, v101
    v_perm_b32 v12, v68, v64, s52
    v_perm_b32 v13, v68, v64, s53
    v_dot2c_f32_bf16 v104, v12, v98
    v_dot2c_f32_bf16 v105, v13, v98
    v_dot2c_f32_bf16 v112, v12, v102
    v_dot2c_f32_bf16 v113, v13, v102
    v_perm_b32 v14, v69, v65, s52
    v_perm_b32 v15, v69, v65, s53
    v_dot2c_f32_bf16 v106, v14, v98
    v_dot2c_f32_bf16 v107, v15, v98
    v_dot2c_f32_bf16 v114, v14, v102
    v_dot2c_f32_bf16 v115, v15, v102
    v_perm_b32 v12, v70, v66, s52
    v_perm_b32 v13, v70, v66, s53
    v_dot2c_f32_bf16 v108, v12, v98
    v_dot2c_f32_bf16 v109, v13, v98
    v_dot2c_f32_bf16 v116, v12, v102
    v_dot2c_f32_bf16 v117, v13, v102
    v_perm_b32 v14, v71, v67, s52
    v_perm_b32 v15, v71, v67, s53
    v_dot2c_f32_bf16 v110, v14, v98
    v_dot2c_f32_bf16 v111, v15, v98
    v_dot2c_f32_bf16 v118, v14, v102
    v_dot2c_f32_bf16 v119, v15, v102
    v_perm_b32 v12, v76, v72, s52
    v_perm_b32 v13, v76, v72, s53
    v_dot2c_f32_bf16 v104, v12, v99
    v_dot2c_f32_bf16 v105, v13, v99
    v_dot2c_f32_bf16 v112, v12, v103
    v_dot2c_f32_bf16 v113, v13, v103
    v_perm_b32 v14, v77, v73, s52
    v_perm_b32 v15, v77, v73, s53
    v_dot2c_f32_bf16 v106, v14, v99
    v_dot2c_f32_bf16 v107, v15, v99
    v_dot2c_f32_bf16 v114, v14, v103
    v_dot2c_f32_bf16 v115, v15, v103
    v_perm_b32 v12, v78, v74, s52
    v_perm_b32 v13, v78, v74, s53
    v_dot2c_f32_bf16 v108, v12, v99
    v_dot2c_f32_bf16 v109, v13, v99
    v_dot2c_f32_bf16 v116, v12, v103
    v_dot2c_f32_bf16 v117, v13, v103
    v_perm_b32 v14, v79, v75, s52
    v_perm_b32 v15, v79, v75, s53
    v_dot2c_f32_bf16 v110, v14, v99
    v_dot2c_f32_bf16 v111, v15, v99
    v_dot2c_f32_bf16 v118, v14, v103
    v_dot2c_f32_bf16 v119, v15, v103
    s_add_u32 s55, s55, 8192
    buffer_load_dwordx4 v[48:51], v1, s[44:47], s55 offen offset:0 nt
    buffer_load_dwordx4 v[52:55], v1, s[44:47], s55 offen offset:1024 nt
    buffer_load_dwordx4 v[56:59], v1, s[44:47], s55 offen offset:2048 nt
    buffer_load_dwordx4 v[60:63], v1, s[44:47], s55 offen offset:3072 nt
    buffer_load_dwordx4 v[64:67], v2, s[44:47], s55 offen offset:0 nt
    buffer_load_dwordx4 v[68:71], v2, s[44:47], s55 offen offset:1024 nt
    buffer_load_dwordx4 v[72:75], v2, s[44:47], s55 offen offset:2048 nt
    buffer_load_dwordx4 v[76:79], v2, s[44:47], s55 offen offset:3072 nt
    s_waitcnt vmcnt(8)
    v_dot2_f32_bf16 v80, v16, v4, 0
    v_dot2_f32_bf16 v88, v16, v8, 0
    v_dot2_f32_bf16 v81, v20, v4, 0
    v_dot2_f32_bf16 v89, v20, v8, 0
    v_dot2_f32_bf16 v82, v24, v4, 0
    v_dot2_f32_bf16 v90, v24, v8, 0
    v_dot2_f32_bf16 v83, v28, v4, 0
    v_dot2_f32_bf16 v91, v28, v8, 0
    v_dot2_f32_bf16 v84, v32, v4, 0
    v_dot2_f32_bf16 v92, v32, v8, 0
    v_dot2_f32_bf16 v85, v36, v4, 0
    v_dot2_f32_bf16 v93, v36, v8, 0
    v_dot2_f32_bf16 v86, v40, v4, 0
    v_dot2_f32_bf16 v94, v40, v8, 0
    v_dot2_f32_bf16 v87, v44, v4, 0
    v_dot2_f32_bf16 v95, v44, v8, 0
    v_dot2c_f32_bf16 v80, v17, v5
    v_dot2c_f32_bf16 v88, v17, v9
    v_dot2c_f32_bf16 v81, v21, v5
    v_dot2c_f32_bf16 v89, v21, v9
    v_dot2c_f32_bf16 v82, v25, v5
    v_dot2c_f32_bf16 v90, v25, v9
    v_dot2c_f32_bf16 v83, v29, v5
    v_dot2c_f32_bf16 v91, v29, v9
    v_dot2c_f32_bf16 v84, v33, v5
    v_dot2c_f32_bf16 v92, v33, v9
    v_dot2c_f32_bf16 v85, v37, v5
    v_dot2c_f32_bf16 v93, v37, v9
    v_dot2c_f32_bf16 v86, v41, v5
    v_dot2c_f32_bf16 v94, v41, v9
    v_dot2c_f32_bf16 v87, v45, v5
    v_dot2c_f32_bf16 v95, v45, v9
    v_dot2c_f32_bf16 v80, v18, v6
    v_dot2c_f32_bf16 v88, v18, v10
    v_dot2c_f32_bf16 v81, v22, v6
    v_dot2c_f32_bf16 v89, v22, v10
    v_dot2c_f32_bf16 v82, v26, v6
    v_dot2c_f32_bf16 v90, v26, v10
    v_dot2c_f32_bf16 v83, v30, v6
    v_dot2c_f32_bf16 v91, v30, v10
    v_dot2c_f32_bf16 v84, v34, v6
    v_dot2c_f32_bf16 v92, v34, v10
    v_dot2c_f32_bf16 v85, v38, v6
    v_dot2c_f32_bf16 v93, v38, v10
    v_dot2c_f32_bf16 v86, v42, v6
    v_dot2c_f32_bf16 v94, v42, v10
    v_dot2c_f32_bf16 v87, v46, v6
    v_dot2c_f32_bf16 v95, v46, v10
    v_dot2c_f32_bf16 v80, v19, v7
    v_dot2c_f32_bf16 v88, v19, v11
    v_dot2c_f32_bf16 v81, v23, v7
    v_dot2c_f32_bf16 v89, v23, v11
    v_dot2c_f32_bf16 v82, v27, v7
    v_dot2c_f32_bf16 v90, v27, v11
    v_dot2c_f32_bf16 v83, v31, v7
    v_dot2c_f32_bf16 v91, v31, v11
    v_dot2c_f32_bf16 v84, v35, v7
    v_dot2c_f32_bf16 v92, v35, v11
    v_dot2c_f32_bf16 v85, v39, v7
    v_dot2c_f32_bf16 v93, v39, v11
    v_dot2c_f32_bf16 v86, v43, v7
    v_dot2c_f32_bf16 v94, v43, v11
    v_dot2c_f32_bf16 v87, v47, v7
    v_dot2c_f32_bf16 v95, v47, v11
    s_add_u32 s54, s54, 8192
    buffer_load_dwordx4 v[16:19], v1, s[40:43], s54 offen offset:0 nt
    buffer_load_dwordx4 v[20:23], v1, s[40:43], s54 offen offset:1024 nt
    buffer_load_dwordx4 v[24:27], v1, s[40:43], s54 offen offset:2048 nt
    buffer_load_dwordx4 v[28:31], v1, s[40:43], s54 offen offset:3072 nt
    buffer_load_dwordx4 v[32:35], v2, s[40:43], s54 offen offset:0 nt
    buffer_load_dwordx4 v[36:39], v2, s[40:43], s54 offen offset:1024 nt
    buffer_load_dwordx4 v[40:43], v2, s[40:43], s54 offen offset:2048 nt
    buffer_load_dwordx4 v[44:47], v2, s[40:43], s54 offen offset:3072 nt
    v_add_f32_dpp v80, v80, v80 row_ror:8 row_mask:0xf bank_mask:0xf
    v_add_f32_dpp v81, v81, v81 row_ror:8 row_mask:0xf bank_mask:0xf
    v_add_f32_dpp v82, v82, v82 row_ror:8 row_mask:0xf bank_mask:0xf
    v_add_f32_dpp v83, v83, v83 row_ror:8 row_mask:0xf bank_mask:0xf
    v_add_f32_dpp v84, v84, v84 row_ror:8 row_mask:0xf bank_mask:0xf
    v_add_f32_dpp v85, v85, v85 row_ror:8 row_mask:0xf bank_mask:0xf
    v_add_f32_dpp v86, v86, v86 row_ror:8 row_mask:0xf bank_mask:0xf
    v_add_f32_dpp v87, v87, v87 row_ror:8 row_mask:0xf bank_mask:0xf
    v_add_f32_dpp v88, v88, v88 row_ror:8 row_mask:0xf bank_mask:0xf
    v_add_f32_dpp v89, v89, v89 row_ror:8 row_mask:0xf bank_mask:0xf
    v_add_f32_dpp v90, v90, v90 row_ror:8 row_mask:0xf bank_mask:0xf
    v_add_f32_dpp v91, v91, v91 row_ror:8 row_mask:0xf bank_mask:0xf
    v_add_f32_dpp v92, v92, v92 row_ror:8 row_mask:0xf bank_mask:0xf
    v_add_f32_dpp v93, v93, v93 row_ror:8 row_mask:0xf bank_mask:0xf
    v_add_f32_dpp v94, v94, v94 row_ror:8 row_mask:0xf bank_mask:0xf
    v_add_f32_dpp v95, v95, v95 row_ror:8 row_mask:0xf bank_mask:0xf
    v_add_f32_dpp v80, v80, v80 row_ror:4 row_mask:0xf bank_mask:0xf
    v_add_f32_dpp v81, v81, v81 row_ror:4 row_mask:0xf bank_mask:0xf
    v_add_f32_dpp v82, v82, v82 row_ror:4 row_mask:0xf bank_mask:0xf
    v_add_f32_dpp v83, v83, v83 row_ror:4 row_mask:0xf bank_mask:0xf
    v_add_f32_dpp v84, v84, v84 row_ror:4 row_mask:0xf bank_mask:0xf
    v_add_f32_dpp v85, v85, v85 row_ror:4 row_mask:0xf bank_mask:0xf
    v_add_f32_dpp v86, v86, v86 row_ror:4 row_mask:0xf bank_mask:0xf
    v_add_f32_dpp v87, v87, v87 row_ror:4 row_mask:0xf bank_mask:0xf
    v_add_f32_dpp v88, v88, v88 row_ror:4 row_mask:0xf bank_mask:0xf
    v_add_f32_dpp v89, v89, v89 row_ror:4 row_mask:0xf bank_mask:0xf
    v_add_f32_dpp v90, v90, v90 row_ror:4 row_mask:0xf bank_mask:0xf
    v_add_f32_dpp v91, v91, v91 row_ror:4 row_mask:0xf bank_mask:0xf
    v_add_f32_dpp v92, v92, v92 row_ror:4 row_mask:0xf bank_mask:0xf
    v_add_f32_dpp v93, v93, v93 row_ror:4 row_mask:0xf bank_mask:0xf
    v_add_f32_dpp v94, v94, v94 row_ror:4 row_mask:0xf bank_mask:0xf
    v_add_f32_dpp v95, v95, v95 row_ror:4 row_mask:0xf bank_mask:0xf
    v_add_f32_dpp v80, v80, v80 row_ror:2 row_mask:0xf bank_mask:0xf
    v_add_f32_dpp v81, v81, v81 row_ror:2 row_mask:0xf bank_mask:0xf
    v_add_f32_dpp v82, v82, v82 row_ror:2 row_mask:0xf bank_mask:0xf
    v_add_f32_dpp v83, v83, v83 row_ror:2 row_mask:0xf bank_mask:0xf
    v_add_f32_dpp v84, v84, v84 row_ror:2 row_mask:0xf bank_mask:0xf
    v_add_f32_dpp v85, v85, v85 row_ror:2 row_mask:0xf bank_mask:0xf
    v_add_f32_dpp v86, v86, v86 row_ror:2 row_mask:0xf bank_mask:0xf
    v_add_f32_dpp v87, v87, v87 row_ror:2 row_mask:0xf bank_mask:0xf
    v_add_f32_dpp v88, v88, v88 row_ror:2 row_mask:0xf bank_mask:0xf
    v_add_f32_dpp v89, v89, v89 row_ror:2 row_mask:0xf bank_mask:0xf
    v_add_f32_dpp v90, v90, v90 row_ror:2 row_mask:0xf bank_mask:0xf
    v_add_f32_dpp v91, v91, v91 row_ror:2 row_mask:0xf bank_mask:0xf
    v_add_f32_dpp v92, v92, v92 row_ror:2 row_mask:0xf bank_mask:0xf
    v_add_f32_dpp v93, v93, v93 row_ror:2 row_mask:0xf bank_mask:0xf
    v_add_f32_dpp v94, v94, v94 row_ror:2 row_mask:0xf bank_mask:0xf
    v_add_f32_dpp v95, v95, v95 row_ror:2 row_mask:0xf bank_mask:0xf
    v_add_f32_dpp v80, v80, v80 row_ror:1 row_mask:0xf bank_mask:0xf
    v_add_f32_dpp v81, v81, v81 row_ror:1 row_mask:0xf bank_mask:0xf
    v_add_f32_dpp v82, v82, v82 row_ror:1 row_mask:0xf bank_mask:0xf
    v_add_f32_dpp v83, v83, v83 row_ror:1 row_mask:0xf bank_mask:0xf
    v_add_f32_dpp v84, v84, v84 row_ror:1 row_mask:0xf bank_mask:0xf
    v_add_f32_dpp v85, v85, v85 row_ror:1 row_mask:0xf bank_mask:0xf
    v_add_f32_dpp v86, v86, v86 row_ror:1 row_mask:0xf bank_mask:0xf
    v_add_f32_dpp v87, v87, v87 row_ror:1 row_mask:0xf bank_mask:0xf
    v_add_f32_dpp v88, v88, v88 row_ror:1 row_mask:0xf bank_mask:0xf
    v_add_f32_dpp v89, v89, v89 row_ror:1 row_mask:0xf bank_mask:0xf
    v_add_f32_dpp v90, v90, v90 row_ror:1 row_mask:0xf bank_mask:0xf
    v_add_f32_dpp v91, v91, v91 row_ror:1 row_mask:0xf bank_mask:0xf
    v_add_f32_dpp v92, v92, v92 row_ror:1 row_mask:0xf bank_mask:0xf
    v_add_f32_dpp v93, v93, v93 row_ror:1 row_mask:0xf bank_mask:0xf
    v_add_f32_dpp v94, v94, v94 row_ror:1 row_mask:0xf bank_mask:0xf
    v_add_f32_dpp v95, v95, v95 row_ror:1 row_mask:0xf bank_mask:0xf
    v_max3_f32 v12, v80, v81, v82
    v_max3_f32 v12, v12, v83, v84
    v_max3_f32 v12, v12, v85, v86
    v_max3_f32 v12, v12, v87, v120
    v_sub_f32 v13, v120, v12
    v_mul_f32 v13, s56, v13
    v_exp_f32 v13, v13
    v_mul_f32 v14, s56, v12
    v_mov_b32 v120, v12
    v_fma_f32 v80, v80, s56, -v14
    v_fma_f32 v81, v81, s56, -v14
    v_fma_f32 v82, v82, s56, -v14
    v_fma_f32 v83, v83, s56, -v14
    v_fma_f32 v84, v84, s56, -v14
    v_fma_f32 v85, v85, s56, -v14
    v_fma_f32 v86, v86, s56, -v14
    v_fma_f32 v87, v87, s56, -v14
    v_exp_f32 v80, v80
    v_exp_f32 v81, v81
    v_exp_f32 v82, v82
    v_exp_f32 v83, v83
    v_exp_f32 v84, v84
    v_exp_f32 v85, v85
    v_exp_f32 v86, v86
    v_exp_f32 v87, v87
    v_mul_f32 v122, v122, v13
    v_mul_f32 v104, v104, v13
    v_mul_f32 v105, v105, v13
    v_mul_f32 v106, v106, v13
    v_mul_f32 v107, v107, v13
    v_mul_f32 v108, v108, v13
    v_mul_f32 v109, v109, v13
    v_mul_f32 v110, v110, v13
    v_mul_f32 v111, v111, v13
    v_add_f32 v122, v122, v80
    v_add_f32 v122, v122, v81
    v_add_f32 v122, v122, v82
    v_add_f32 v122, v122, v83
    v_add_f32 v122, v122, v84
    v_add_f32 v122, v122, v85
    v_add_f32 v122, v122, v86
    v_add_f32 v122, v122, v87
    v_cvt_pk_bf16_f32 v96, v80, v81
    v_cvt_pk_bf16_f32 v97, v82, v83
    v_cvt_pk_bf16_f32 v98, v84, v85
    v_cvt_pk_bf16_f32 v99, v86, v87
    v_max3_f32 v12, v88, v89, v90
    v_max3_f32 v12, v12, v91, v92
    v_max3_f32 v12, v12, v93, v94
    v_max3_f32 v12, v12, v95, v121
    v_sub_f32 v13, v121, v12
    v_mul_f32 v13, s56, v13
    v_exp_f32 v13, v13
    v_mul_f32 v14, s56, v12
    v_mov_b32 v121, v12
    v_fma_f32 v88, v88, s56, -v14
    v_fma_f32 v89, v89, s56, -v14
    v_fma_f32 v90, v90, s56, -v14
    v_fma_f32 v91, v91, s56, -v14
    v_fma_f32 v92, v92, s56, -v14
    v_fma_f32 v93, v93, s56, -v14
    v_fma_f32 v94, v94, s56, -v14
    v_fma_f32 v95, v95, s56, -v14
    v_exp_f32 v88, v88
    v_exp_f32 v89, v89
    v_exp_f32 v90, v90
    v_exp_f32 v91, v91
    v_exp_f32 v92, v92
    v_exp_f32 v93, v93
    v_exp_f32 v94, v94
    v_exp_f32 v95, v95
    v_mul_f32 v123, v123, v13
    v_mul_f32 v112, v112, v13
    v_mul_f32 v113, v113, v13
    v_mul_f32 v114, v114, v13
    v_mul_f32 v115, v115, v13
    v_mul_f32 v116, v116, v13
    v_mul_f32 v117, v117, v13
    v_mul_f32 v118, v118, v13
    v_mul_f32 v119, v119, v13
    v_add_f32 v123, v123, v88
    v_add_f32 v123, v123, v89
    v_add_f32 v123, v123, v90
    v_add_f32 v123, v123, v91
    v_add_f32 v123, v123, v92
    v_add_f32 v123, v123, v93
    v_add_f32 v123, v123, v94
    v_add_f32 v123, v123, v95
    v_cvt_pk_bf16_f32 v100, v88, v89
    v_cvt_pk_bf16_f32 v101, v90, v91
    v_cvt_pk_bf16_f32 v102, v92, v93
    v_cvt_pk_bf16_f32 v103, v94, v95
    s_waitcnt vmcnt(8)
    v_perm_b32 v12, v52, v48, s52
    v_perm_b32 v13, v52, v48, s53
    v_dot2c_f32_bf16 v104, v12, v96
    v_dot2c_f32_bf16 v105, v13, v96
    v_dot2c_f32_bf16 v112, v12, v100
    v_dot2c_f32_bf16 v113, v13, v100
    v_perm_b32 v14, v53, v49, s52
    v_perm_b32 v15, v53, v49, s53
    v_dot2c_f32_bf16 v106, v14, v96
    v_dot2c_f32_bf16 v107, v15, v96
    v_dot2c_f32_bf16 v114, v14, v100
    v_dot2c_f32_bf16 v115, v15, v100
    v_perm_b32 v12, v54, v50, s52
    v_perm_b32 v13, v54, v50, s53
    v_dot2c_f32_bf16 v108, v12, v96
    v_dot2c_f32_bf16 v109, v13, v96
    v_dot2c_f32_bf16 v116, v12, v100
    v_dot2c_f32_bf16 v117, v13, v100
    v_perm_b32 v14, v55, v51, s52
    v_perm_b32 v15, v55, v51, s53
    v_dot2c_f32_bf16 v110, v14, v96
    v_dot2c_f32_bf16 v111, v15, v96
    v_dot2c_f32_bf16 v118, v14, v100
    v_dot2c_f32_bf16 v119, v15, v100
    v_perm_b32 v12, v60, v56, s52
    v_perm_b32 v13, v60, v56, s53
    v_dot2c_f32_bf16 v104, v12, v97
    v_dot2c_f32_bf16 v105, v13, v97
    v_dot2c_f32_bf16 v112, v12, v101
    v_dot2c_f32_bf16 v113, v13, v101
    v_perm_b32 v14, v61, v57, s52
    v_perm_b32 v15, v61, v57, s53
    v_dot2c_f32_bf16 v106, v14, v97
    v_dot2c_f32_bf16 v107, v15, v97
    v_dot2c_f32_bf16 v114, v14, v101
    v_dot2c_f32_bf16 v115, v15, v101
    v_perm_b32 v12, v62, v58, s52
    v_perm_b32 v13, v62, v58, s53
    v_dot2c_f32_bf16 v108, v12, v97
    v_dot2c_f32_bf16 v109, v13, v97
    v_dot2c_f32_bf16 v116, v12, v101
    v_dot2c_f32_bf16 v117, v13, v101
    v_perm_b32 v14, v63, v59, s52
    v_perm_b32 v15, v63, v59, s53
    v_dot2c_f32_bf16 v110, v14, v97
    v_dot2c_f32_bf16 v111, v15, v97
    v_dot2c_f32_bf16 v118, v14, v101
    v_dot2c_f32_bf16 v119, v15, v101
    v_perm_b32 v12, v68, v64, s52
    v_perm_b32 v13, v68, v64, s53
    v_dot2c_f32_bf16 v104, v12, v98
    v_dot2c_f32_bf16 v105, v13, v98
    v_dot2c_f32_bf16 v112, v12, v102
    v_dot2c_f32_bf16 v113, v13, v102
    v_perm_b32 v14, v69, v65, s52
    v_perm_b32 v15, v69, v65, s53
    v_dot2c_f32_bf16 v106, v14, v98
    v_dot2c_f32_bf16 v107, v15, v98
    v_dot2c_f32_bf16 v114, v14, v102
    v_dot2c_f32_bf16 v115, v15, v102
    v_perm_b32 v12, v70, v66, s52
    v_perm_b32 v13, v70, v66, s53
    v_dot2c_f32_bf16 v108, v12, v98
    v_dot2c_f32_bf16 v109, v13, v98
    v_dot2c_f32_bf16 v116, v12, v102
    v_dot2c_f32_bf16 v117, v13, v102
    v_perm_b32 v14, v71, v67, s52
    v_perm_b32 v15, v71, v67, s53
    v_dot2c_f32_bf16 v110, v14, v98
    v_dot2c_f32_bf16 v111, v15, v98
    v_dot2c_f32_bf16 v118, v14, v102
    v_dot2c_f32_bf16 v119, v15, v102
    v_perm_b32 v12, v76, v72, s52
    v_perm_b32 v13, v76, v72, s53
    v_dot2c_f32_bf16 v104, v12, v99
    v_dot2c_f32_bf16 v105, v13, v99
    v_dot2c_f32_bf16 v112, v12, v103
    v_dot2c_f32_bf16 v113, v13, v103
    v_perm_b32 v14, v77, v73, s52
    v_perm_b32 v15, v77, v73, s53
    v_dot2c_f32_bf16 v106, v14, v99
    v_dot2c_f32_bf16 v107, v15, v99
    v_dot2c_f32_bf16 v114, v14, v103
    v_dot2c_f32_bf16 v115, v15, v103
    v_perm_b32 v12, v78, v74, s52
    v_perm_b32 v13, v78, v74, s53
    v_dot2c_f32_bf16 v108, v12, v99
    v_dot2c_f32_bf16 v109, v13, v99
    v_dot2c_f32_bf16 v116, v12, v103
    v_dot2c_f32_bf16 v117, v13, v103
    v_perm_b32 v14, v79, v75, s52
    v_perm_b32 v15, v79, v75, s53
    v_dot2c_f32_bf16 v110, v14, v99
    v_dot2c_f32_bf16 v111, v15, v99
    v_dot2c_f32_bf16 v118, v14, v103
    v_dot2c_f32_bf16 v119, v15, v103
    s_add_u32 s55, s55, 8192
    buffer_load_dwordx4 v[48:51], v1, s[44:47], s55 offen offset:0 nt
    buffer_load_dwordx4 v[52:55], v1, s[44:47], s55 offen offset:1024 nt
    buffer_load_dwordx4 v[56:59], v1, s[44:47], s55 offen offset:2048 nt
    buffer_load_dwordx4 v[60:63], v1, s[44:47], s55 offen offset:3072 nt
    buffer_load_dwordx4 v[64:67], v2, s[44:47], s55 offen offset:0 nt
    buffer_load_dwordx4 v[68:71], v2, s[44:47], s55 offen offset:1024 nt
    buffer_load_dwordx4 v[72:75], v2, s[44:47], s55 offen offset:2048 nt
    buffer_load_dwordx4 v[76:79], v2, s[44:47], s55 offen offset:3072 nt
    s_waitcnt vmcnt(8)
    v_dot2_f32_bf16 v80, v16, v4, 0
    v_dot2_f32_bf16 v88, v16, v8, 0
    v_dot2_f32_bf16 v81, v20, v4, 0
    v_dot2_f32_bf16 v89, v20, v8, 0
    v_dot2_f32_bf16 v82, v24, v4, 0
    v_dot2_f32_bf16 v90, v24, v8, 0
    v_dot2_f32_bf16 v83, v28, v4, 0
    v_dot2_f32_bf16 v91, v28, v8, 0
    v_dot2_f32_bf16 v84, v32, v4, 0
    v_dot2_f32_bf16 v92, v32, v8, 0
    v_dot2_f32_bf16 v85, v36, v4, 0
    v_dot2_f32_bf16 v93, v36, v8, 0
    v_dot2_f32_bf16 v86, v40, v4, 0
    v_dot2_f32_bf16 v94, v40, v8, 0
    v_dot2_f32_bf16 v87, v44, v4, 0
    v_dot2_f32_bf16 v95, v44, v8, 0
    v_dot2c_f32_bf16 v80, v17, v5
    v_dot2c_f32_bf16 v88, v17, v9
    v_dot2c_f32_bf16 v81, v21, v5
    v_dot2c_f32_bf16 v89, v21, v9
    v_dot2c_f32_bf16 v82, v25, v5
    v_dot2c_f32_bf16 v90, v25, v9
    v_dot2c_f32_bf16 v83, v29, v5
    v_dot2c_f32_bf16 v91, v29, v9
    v_dot2c_f32_bf16 v84, v33, v5
    v_dot2c_f32_bf16 v92, v33, v9
    v_dot2c_f32_bf16 v85, v37, v5
    v_dot2c_f32_bf16 v93, v37, v9
    v_dot2c_f32_bf16 v86, v41, v5
    v_dot2c_f32_bf16 v94, v41, v9
    v_dot2c_f32_bf16 v87, v45, v5
    v_dot2c_f32_bf16 v95, v45, v9
    v_dot2c_f32_bf16 v80, v18, v6
    v_dot2c_f32_bf16 v88, v18, v10
    v_dot2c_f32_bf16 v81, v22, v6
    v_dot2c_f32_bf16 v89, v22, v10
    v_dot2c_f32_bf16 v82, v26, v6
    v_dot2c_f32_bf16 v90, v26, v10
    v_dot2c_f32_bf16 v83, v30, v6
    v_dot2c_f32_bf16 v91, v30, v10
    v_dot2c_f32_bf16 v84, v34, v6
    v_dot2c_f32_bf16 v92, v34, v10
    v_dot2c_f32_bf16 v85, v38, v6
    v_dot2c_f32_bf16 v93, v38, v10
    v_dot2c_f32_bf16 v86, v42, v6
    v_dot2c_f32_bf16 v94, v42, v10
    v_dot2c_f32_bf16 v87, v46, v6
    v_dot2c_f32_bf16 v95, v46, v10
    v_dot2c_f32_bf16 v80, v19, v7
    v_dot2c_f32_bf16 v88, v19, v11
    v_dot2c_f32_bf16 v81, v23, v7
    v_dot2c_f32_bf16 v89, v23, v11
    v_dot2c_f32_bf16 v82, v27, v7
    v_dot2c_f32_bf16 v90, v27, v11
    v_dot2c_f32_bf16 v83, v31, v7
    v_dot2c_f32_bf16 v91, v31, v11
    v_dot2c_f32_bf16 v84, v35, v7
    v_dot2c_f32_bf16 v92, v35, v11
    v_dot2c_f32_bf16 v85, v39, v7
    v_dot2c_f32_bf16 v93, v39, v11
    v_dot2c_f32_bf16 v86, v43, v7
    v_dot2c_f32_bf16 v94, v43, v11
    v_dot2c_f32_bf16 v87, v47, v7
    v_dot2c_f32_bf16 v95, v47, v11
    s_nop 2
    v_add_f32_dpp v80, v80, v80 row_ror:8 row_mask:0xf bank_mask:0xf
    v_add_f32_dpp v81, v81, v81 row_ror:8 row_mask:0xf bank_mask:0xf
    v_add_f32_dpp v82, v82, v82 row_ror:8 row_mask:0xf bank_mask:0xf
    v_add_f32_dpp v83, v83, v83 row_ror:8 row_mask:0xf bank_mask:0xf
    v_add_f32_dpp v84, v84, v84 row_ror:8 row_mask:0xf bank_mask:0xf
    v_add_f32_dpp v85, v85, v85 row_ror:8 row_mask:0xf bank_mask:0xf
    v_add_f32_dpp v86, v86, v86 row_ror:8 row_mask:0xf bank_mask:0xf
    v_add_f32_dpp v87, v87, v87 row_ror:8 row_mask:0xf bank_mask:0xf
    v_add_f32_dpp v88, v88, v88 row_ror:8 row_mask:0xf bank_mask:0xf
    v_add_f32_dpp v89, v89, v89 row_ror:8 row_mask:0xf bank_mask:0xf
    v_add_f32_dpp v90, v90, v90 row_ror:8 row_mask:0xf bank_mask:0xf
    v_add_f32_dpp v91, v91, v91 row_ror:8 row_mask:0xf bank_mask:0xf
    v_add_f32_dpp v92, v92, v92 row_ror:8 row_mask:0xf bank_mask:0xf
    v_add_f32_dpp v93, v93, v93 row_ror:8 row_mask:0xf bank_mask:0xf
    v_add_f32_dpp v94, v94, v94 row_ror:8 row_mask:0xf bank_mask:0xf
    v_add_f32_dpp v95, v95, v95 row_ror:8 row_mask:0xf bank_mask:0xf
    v_add_f32_dpp v80, v80, v80 row_ror:4 row_mask:0xf bank_mask:0xf
    v_add_f32_dpp v81, v81, v81 row_ror:4 row_mask:0xf bank_mask:0xf
    v_add_f32_dpp v82, v82, v82 row_ror:4 row_mask:0xf bank_mask:0xf
    v_add_f32_dpp v83, v83, v83 row_ror:4 row_mask:0xf bank_mask:0xf
    v_add_f32_dpp v84, v84, v84 row_ror:4 row_mask:0xf bank_mask:0xf
    v_add_f32_dpp v85, v85, v85 row_ror:4 row_mask:0xf bank_mask:0xf
    v_add_f32_dpp v86, v86, v86 row_ror:4 row_mask:0xf bank_mask:0xf
    v_add_f32_dpp v87, v87, v87 row_ror:4 row_mask:0xf bank_mask:0xf
    v_add_f32_dpp v88, v88, v88 row_ror:4 row_mask:0xf bank_mask:0xf
    v_add_f32_dpp v89, v89, v89 row_ror:4 row_mask:0xf bank_mask:0xf
    v_add_f32_dpp v90, v90, v90 row_ror:4 row_mask:0xf bank_mask:0xf
    v_add_f32_dpp v91, v91, v91 row_ror:4 row_mask:0xf bank_mask:0xf
    v_add_f32_dpp v92, v92, v92 row_ror:4 row_mask:0xf bank_mask:0xf
    v_add_f32_dpp v93, v93, v93 row_ror:4 row_mask:0xf bank_mask:0xf
    v_add_f32_dpp v94, v94, v94 row_ror:4 row_mask:0xf bank_mask:0xf
    v_add_f32_dpp v95, v95, v95 row_ror:4 row_mask:0xf bank_mask:0xf
    v_add_f32_dpp v80, v80, v80 row_ror:2 row_mask:0xf bank_mask:0xf
    v_add_f32_dpp v81, v81, v81 row_ror:2 row_mask:0xf bank_mask:0xf
    v_add_f32_dpp v82, v82, v82 row_ror:2 row_mask:0xf bank_mask:0xf
    v_add_f32_dpp v83, v83, v83 row_ror:2 row_mask:0xf bank_mask:0xf
    v_add_f32_dpp v84, v84, v84 row_ror:2 row_mask:0xf bank_mask:0xf
    v_add_f32_dpp v85, v85, v85 row_ror:2 row_mask:0xf bank_mask:0xf
    v_add_f32_dpp v86, v86, v86 row_ror:2 row_mask:0xf bank_mask:0xf
    v_add_f32_dpp v87, v87, v87 row_ror:2 row_mask:0xf bank_mask:0xf
    v_add_f32_dpp v88, v88, v88 row_ror:2 row_mask:0xf bank_mask:0xf
    v_add_f32_dpp v89, v89, v89 row_ror:2 row_mask:0xf bank_mask:0xf
    v_add_f32_dpp v90, v90, v90 row_ror:2 row_mask:0xf bank_mask:0xf
    v_add_f32_dpp v91, v91, v91 row_ror:2 row_mask:0xf bank_mask:0xf
    v_add_f32_dpp v92, v92, v92 row_ror:2 row_mask:0xf bank_mask:0xf
    v_add_f32_dpp v93, v93, v93 row_ror:2 row_mask:0xf bank_mask:0xf
    v_add_f32_dpp v94, v94, v94 row_ror:2 row_mask:0xf bank_mask:0xf
    v_add_f32_dpp v95, v95, v95 row_ror:2 row_mask:0xf bank_mask:0xf
    v_add_f32_dpp v80, v80, v80 row_ror:1 row_mask:0xf bank_mask:0xf
    v_add_f32_dpp v81, v81, v81 row_ror:1 row_mask:0xf bank_mask:0xf
    v_add_f32_dpp v82, v82, v82 row_ror:1 row_mask:0xf bank_mask:0xf
    v_add_f32_dpp v83, v83, v83 row_ror:1 row_mask:0xf bank_mask:0xf
    v_add_f32_dpp v84, v84, v84 row_ror:1 row_mask:0xf bank_mask:0xf
    v_add_f32_dpp v85, v85, v85 row_ror:1 row_mask:0xf bank_mask:0xf
    v_add_f32_dpp v86, v86, v86 row_ror:1 row_mask:0xf bank_mask:0xf
    v_add_f32_dpp v87, v87, v87 row_ror:1 row_mask:0xf bank_mask:0xf
    v_add_f32_dpp v88, v88, v88 row_ror:1 row_mask:0xf bank_mask:0xf
    v_add_f32_dpp v89, v89, v89 row_ror:1 row_mask:0xf bank_mask:0xf
    v_add_f32_dpp v90, v90, v90 row_ror:1 row_mask:0xf bank_mask:0xf
    v_add_f32_dpp v91, v91, v91 row_ror:1 row_mask:0xf bank_mask:0xf
    v_add_f32_dpp v92, v92, v92 row_ror:1 row_mask:0xf bank_mask:0xf
    v_add_f32_dpp v93, v93, v93 row_ror:1 row_mask:0xf bank_mask:0xf
    v_add_f32_dpp v94, v94, v94 row_ror:1 row_mask:0xf bank_mask:0xf
    v_add_f32_dpp v95, v95, v95 row_ror:1 row_mask:0xf bank_mask:0xf
    v_max3_f32 v12, v80, v81, v82
    v_max3_f32 v12, v12, v83, v84
    v_max3_f32 v12, v12, v85, v86
    v_max3_f32 v12, v12, v87, v120
    v_sub_f32 v13, v120, v12
    v_mul_f32 v13, s56, v13
    v_exp_f32 v13, v13
    v_mul_f32 v14, s56, v12
    v_mov_b32 v120, v12
    v_fma_f32 v80, v80, s56, -v14
    v_fma_f32 v81, v81, s56, -v14
    v_fma_f32 v82, v82, s56, -v14
    v_fma_f32 v83, v83, s56, -v14
    v_fma_f32 v84, v84, s56, -v14
    v_fma_f32 v85, v85, s56, -v14
    v_fma_f32 v86, v86, s56, -v14
    v_fma_f32 v87, v87, s56, -v14
    v_exp_f32 v80, v80
    v_exp_f32 v81, v81
    v_exp_f32 v82, v82
    v_exp_f32 v83, v83
    v_exp_f32 v84, v84
    v_exp_f32 v85, v85
    v_exp_f32 v86, v86
    v_exp_f32 v87, v87
    v_mul_f32 v122, v122, v13
    v_mul_f32 v104, v104, v13
    v_mul_f32 v105, v105, v13
    v_mul_f32 v106, v106, v13
    v_mul_f32 v107, v107, v13
    v_mul_f32 v108, v108, v13
    v_mul_f32 v109, v109, v13
    v_mul_f32 v110, v110, v13
    v_mul_f32 v111, v111, v13
    v_add_f32 v122, v122, v80
    v_add_f32 v122, v122, v81
    v_add_f32 v122, v122, v82
    v_add_f32 v122, v122, v83
    v_add_f32 v122, v122, v84
    v_add_f32 v122, v122, v85
    v_add_f32 v122, v122, v86
    v_add_f32 v122, v122, v87
    v_cvt_pk_bf16_f32 v96, v80, v81
    v_cvt_pk_bf16_f32 v97, v82, v83
    v_cvt_pk_bf16_f32 v98, v84, v85
    v_cvt_pk_bf16_f32 v99, v86, v87
    v_max3_f32 v12, v88, v89, v90
    v_max3_f32 v12, v12, v91, v92
    v_max3_f32 v12, v12, v93, v94
    v_max3_f32 v12, v12, v95, v121
    v_sub_f32 v13, v121, v12
    v_mul_f32 v13, s56, v13
    v_exp_f32 v13, v13
    v_mul_f32 v14, s56, v12
    v_mov_b32 v121, v12
    v_fma_f32 v88, v88, s56, -v14
    v_fma_f32 v89, v89, s56, -v14
    v_fma_f32 v90, v90, s56, -v14
    v_fma_f32 v91, v91, s56, -v14
    v_fma_f32 v92, v92, s56, -v14
    v_fma_f32 v93, v93, s56, -v14
    v_fma_f32 v94, v94, s56, -v14
    v_fma_f32 v95, v95, s56, -v14
    v_exp_f32 v88, v88
    v_exp_f32 v89, v89
    v_exp_f32 v90, v90
    v_exp_f32 v91, v91
    v_exp_f32 v92, v92
    v_exp_f32 v93, v93
    v_exp_f32 v94, v94
    v_exp_f32 v95, v95
    v_mul_f32 v123, v123, v13
    v_mul_f32 v112, v112, v13
    v_mul_f32 v113, v113, v13
    v_mul_f32 v114, v114, v13
    v_mul_f32 v115, v115, v13
    v_mul_f32 v116, v116, v13
    v_mul_f32 v117, v117, v13
    v_mul_f32 v118, v118, v13
    v_mul_f32 v119, v119, v13
    v_add_f32 v123, v123, v88
    v_add_f32 v123, v123, v89
    v_add_f32 v123, v123, v90
    v_add_f32 v123, v123, v91
    v_add_f32 v123, v123, v92
    v_add_f32 v123, v123, v93
    v_add_f32 v123, v123, v94
    v_add_f32 v123, v123, v95
    v_cvt_pk_bf16_f32 v100, v88, v89
    v_cvt_pk_bf16_f32 v101, v90, v91
    v_cvt_pk_bf16_f32 v102, v92, v93
    v_cvt_pk_bf16_f32 v103, v94, v95
    s_waitcnt vmcnt(0)
    v_perm_b32 v12, v52, v48, s52
    v_perm_b32 v13, v52, v48, s53
    v_dot2c_f32_bf16 v104, v12, v96
    v_dot2c_f32_bf16 v105, v13, v96
    v_dot2c_f32_bf16 v112, v12, v100
    v_dot2c_f32_bf16 v113, v13, v100
    v_perm_b32 v14, v53, v49, s52
    v_perm_b32 v15, v53, v49, s53
    v_dot2c_f32_bf16 v106, v14, v96
    v_dot2c_f32_bf16 v107, v15, v96
    v_dot2c_f32_bf16 v114, v14, v100
    v_dot2c_f32_bf16 v115, v15, v100
    v_perm_b32 v12, v54, v50, s52
    v_perm_b32 v13, v54, v50, s53
    v_dot2c_f32_bf16 v108, v12, v96
    v_dot2c_f32_bf16 v109, v13, v96
    v_dot2c_f32_bf16 v116, v12, v100
    v_dot2c_f32_bf16 v117, v13, v100
    v_perm_b32 v14, v55, v51, s52
    v_perm_b32 v15, v55, v51, s53
    v_dot2c_f32_bf16 v110, v14, v96
    v_dot2c_f32_bf16 v111, v15, v96
    v_dot2c_f32_bf16 v118, v14, v100
    v_dot2c_f32_bf16 v119, v15, v100
    v_perm_b32 v12, v60, v56, s52
    v_perm_b32 v13, v60, v56, s53
    v_dot2c_f32_bf16 v104, v12, v97
    v_dot2c_f32_bf16 v105, v13, v97
    v_dot2c_f32_bf16 v112, v12, v101
    v_dot2c_f32_bf16 v113, v13, v101
    v_perm_b32 v14, v61, v57, s52
    v_perm_b32 v15, v61, v57, s53
    v_dot2c_f32_bf16 v106, v14, v97
    v_dot2c_f32_bf16 v107, v15, v97
    v_dot2c_f32_bf16 v114, v14, v101
    v_dot2c_f32_bf16 v115, v15, v101
    v_perm_b32 v12, v62, v58, s52
    v_perm_b32 v13, v62, v58, s53
    v_dot2c_f32_bf16 v108, v12, v97
    v_dot2c_f32_bf16 v109, v13, v97
    v_dot2c_f32_bf16 v116, v12, v101
    v_dot2c_f32_bf16 v117, v13, v101
    v_perm_b32 v14, v63, v59, s52
    v_perm_b32 v15, v63, v59, s53
    v_dot2c_f32_bf16 v110, v14, v97
    v_dot2c_f32_bf16 v111, v15, v97
    v_dot2c_f32_bf16 v118, v14, v101
    v_dot2c_f32_bf16 v119, v15, v101
    v_perm_b32 v12, v68, v64, s52
    v_perm_b32 v13, v68, v64, s53
    v_dot2c_f32_bf16 v104, v12, v98
    v_dot2c_f32_bf16 v105, v13, v98
    v_dot2c_f32_bf16 v112, v12, v102
    v_dot2c_f32_bf16 v113, v13, v102
    v_perm_b32 v14, v69, v65, s52
    v_perm_b32 v15, v69, v65, s53
    v_dot2c_f32_bf16 v106, v14, v98
    v_dot2c_f32_bf16 v107, v15, v98
    v_dot2c_f32_bf16 v114, v14, v102
    v_dot2c_f32_bf16 v115, v15, v102
    v_perm_b32 v12, v70, v66, s52
    v_perm_b32 v13, v70, v66, s53
    v_dot2c_f32_bf16 v108, v12, v98
    v_dot2c_f32_bf16 v109, v13, v98
    v_dot2c_f32_bf16 v116, v12, v102
    v_dot2c_f32_bf16 v117, v13, v102
    v_perm_b32 v14, v71, v67, s52
    v_perm_b32 v15, v71, v67, s53
    v_dot2c_f32_bf16 v110, v14, v98
    v_dot2c_f32_bf16 v111, v15, v98
    v_dot2c_f32_bf16 v118, v14, v102
    v_dot2c_f32_bf16 v119, v15, v102
    v_perm_b32 v12, v76, v72, s52
    v_perm_b32 v13, v76, v72, s53
    v_dot2c_f32_bf16 v104, v12, v99
    v_dot2c_f32_bf16 v105, v13, v99
    v_dot2c_f32_bf16 v112, v12, v103
    v_dot2c_f32_bf16 v113, v13, v103
    v_perm_b32 v14, v77, v73, s52
    v_perm_b32 v15, v77, v73, s53
    v_dot2c_f32_bf16 v106, v14, v99
    v_dot2c_f32_bf16 v107, v15, v99
    v_dot2c_f32_bf16 v114, v14, v103
    v_dot2c_f32_bf16 v115, v15, v103
    v_perm_b32 v12, v78, v74, s52
    v_perm_b32 v13, v78, v74, s53
    v_dot2c_f32_bf16 v108, v12, v99
    v_dot2c_f32_bf16 v109, v13, v99
    v_dot2c_f32_bf16 v116, v12, v103
    v_dot2c_f32_bf16 v117, v13, v103
    v_perm_b32 v14, v79, v75, s52
    v_perm_b32 v15, v79, v75, s53
    v_dot2c_f32_bf16 v110, v14, v99
    v_dot2c_f32_bf16 v111, v15, v99
    v_dot2c_f32_bf16 v118, v14, v103
    v_dot2c_f32_bf16 v119, v15, v103
    s_nop 3
    v_lshrrev_b32 v12, 4, v0
    v_lshlrev_b32 v13, 10, v12
    v_and_b32 v14, 15, v0
    v_lshlrev_b32 v14, 5, v14
    v_add_u32 v13, v13, v14
    ds_write_b128 v13, v[104:107]
    ds_write_b128 v13, v[108:111] offset:16
    ds_write_b128 v13, v[112:115] offset:512
    ds_write_b128 v13, v[116:119] offset:528
    v_lshlrev_b32 v14, 4, v12
    ds_write_b128 v14, v[120:123] offset:16384
    s_waitcnt lgkmcnt(0)
    s_barrier
    v_lshrrev_b32 v12, 7, v0
    v_lshlrev_b32 v13, 2, v12
    v_add_u32 v13, 0x4000, v13
    ds_read2_b32 v[16:17], v13 offset0:0 offset1:2
    ds_read2_b32 v[18:19], v13 offset0:4 offset1:6
    ds_read2_b32 v[20:21], v13 offset0:8 offset1:10
    ds_read2_b32 v[22:23], v13 offset0:12 offset1:14
    ds_read2_b32 v[24:25], v13 offset0:16 offset1:18
    ds_read2_b32 v[26:27], v13 offset0:20 offset1:22
    ds_read2_b32 v[28:29], v13 offset0:24 offset1:26
    ds_read2_b32 v[30:31], v13 offset0:28 offset1:30
    ds_read2_b32 v[32:33], v13 offset0:32 offset1:34
    ds_read2_b32 v[34:35], v13 offset0:36 offset1:38
    ds_read2_b32 v[36:37], v13 offset0:40 offset1:42
    ds_read2_b32 v[38:39], v13 offset0:44 offset1:46
    ds_read2_b32 v[40:41], v13 offset0:48 offset1:50
    ds_read2_b32 v[42:43], v13 offset0:52 offset1:54
    ds_read2_b32 v[44:45], v13 offset0:56 offset1:58
    ds_read2_b32 v[46:47], v13 offset0:60 offset1:62
    v_lshlrev_b32 v14, 2, v0
    ds_read_b32 v48, v14 offset:0
    ds_read_b32 v49, v14 offset:1024
    ds_read_b32 v50, v14 offset:2048
    ds_read_b32 v51, v14 offset:3072
    ds_read_b32 v52, v14 offset:4096
    ds_read_b32 v53, v14 offset:5120
    ds_read_b32 v54, v14 offset:6144
    ds_read_b32 v55, v14 offset:7168
    ds_read_b32 v56, v14 offset:8192
    ds_read_b32 v57, v14 offset:9216
    ds_read_b32 v58, v14 offset:10240
    ds_read_b32 v59, v14 offset:11264
    ds_read_b32 v60, v14 offset:12288
    ds_read_b32 v61, v14 offset:13312
    ds_read_b32 v62, v14 offset:14336
    ds_read_b32 v63, v14 offset:15360
    s_waitcnt lgkmcnt(0)
    v_max3_f32 v64, v16, v18, v20
    v_max3_f32 v64, v64, v22, v24
    v_max3_f32 v64, v64, v26, v28
    v_max3_f32 v64, v64, v30, v32
    v_max3_f32 v64, v64, v34, v36
    v_max3_f32 v64, v64, v38, v40
    v_max3_f32 v64, v64, v42, v44
    v_max_f32 v64, v64, v46
    v_mov_b32 v65, 0
    v_mov_b32 v66, 0
    v_sub_f32 v16, v16, v64
    v_mul_f32 v16, s56, v16
    v_exp_f32 v16, v16
    v_sub_f32 v18, v18, v64
    v_mul_f32 v18, s56, v18
    v_exp_f32 v18, v18
    v_sub_f32 v20, v20, v64
    v_mul_f32 v20, s56, v20
    v_exp_f32 v20, v20
    v_sub_f32 v22, v22, v64
    v_mul_f32 v22, s56, v22
    v_exp_f32 v22, v22
    v_sub_f32 v24, v24, v64
    v_mul_f32 v24, s56, v24
    v_exp_f32 v24, v24
    v_sub_f32 v26, v26, v64
    v_mul_f32 v26, s56, v26
    v_exp_f32 v26, v26
    v_sub_f32 v28, v28, v64
    v_mul_f32 v28, s56, v28
    v_exp_f32 v28, v28
    v_sub_f32 v30, v30, v64
    v_mul_f32 v30, s56, v30
    v_exp_f32 v30, v30
    v_sub_f32 v32, v32, v64
    v_mul_f32 v32, s56, v32
    v_exp_f32 v32, v32
    v_sub_f32 v34, v34, v64
    v_mul_f32 v34, s56, v34
    v_exp_f32 v34, v34
    v_sub_f32 v36, v36, v64
    v_mul_f32 v36, s56, v36
    v_exp_f32 v36, v36
    v_sub_f32 v38, v38, v64
    v_mul_f32 v38, s56, v38
    v_exp_f32 v38, v38
    v_sub_f32 v40, v40, v64
    v_mul_f32 v40, s56, v40
    v_exp_f32 v40, v40
    v_sub_f32 v42, v42, v64
    v_mul_f32 v42, s56, v42
    v_exp_f32 v42, v42
    v_sub_f32 v44, v44, v64
    v_mul_f32 v44, s56, v44
    v_exp_f32 v44, v44
    v_sub_f32 v46, v46, v64
    v_mul_f32 v46, s56, v46
    v_exp_f32 v46, v46
    s_nop 0
    v_fmac_f32 v65, v16, v17
    v_fmac_f32 v66, v16, v48
    v_fmac_f32 v65, v18, v19
    v_fmac_f32 v66, v18, v49
    v_fmac_f32 v65, v20, v21
    v_fmac_f32 v66, v20, v50
    v_fmac_f32 v65, v22, v23
    v_fmac_f32 v66, v22, v51
    v_fmac_f32 v65, v24, v25
    v_fmac_f32 v66, v24, v52
    v_fmac_f32 v65, v26, v27
    v_fmac_f32 v66, v26, v53
    v_fmac_f32 v65, v28, v29
    v_fmac_f32 v66, v28, v54
    v_fmac_f32 v65, v30, v31
    v_fmac_f32 v66, v30, v55
    v_fmac_f32 v65, v32, v33
    v_fmac_f32 v66, v32, v56
    v_fmac_f32 v65, v34, v35
    v_fmac_f32 v66, v34, v57
    v_fmac_f32 v65, v36, v37
    v_fmac_f32 v66, v36, v58
    v_fmac_f32 v65, v38, v39
    v_fmac_f32 v66, v38, v59
    v_fmac_f32 v65, v40, v41
    v_fmac_f32 v66, v40, v60
    v_fmac_f32 v65, v42, v43
    v_fmac_f32 v66, v42, v61
    v_fmac_f32 v65, v44, v45
    v_fmac_f32 v66, v44, v62
    v_fmac_f32 v65, v46, v47
    v_fmac_f32 v66, v46, v63
    s_lshl_b32 s59, s57, 16
    s_lshl_b32 s60, s58, 9
    s_add_u32 s59, s59, s60
    s_add_u32 s59, s59, 65536
    v_lshlrev_b32 v13, 15, v12
    v_and_b32 v14, 127, v0
    v_lshlrev_b32 v15, 2, v14
    v_add_u32 v13, v13, v15
    buffer_store_dword v66, v13, s[48:51], s59 offen
    s_lshl_b32 s59, s57, 10
    s_lshl_b32 s60, s58, 3
    s_add_u32 s59, s59, s60
    s_add_u32 s59, s59, 32768
    v_lshlrev_b32 v13, 9, v12
    v_cmp_eq_u32 vcc, 0, v14
    s_and_saveexec_b64 s[60:61], vcc
    s_cbranch_execz K2_exit
    buffer_store_dwordx2 v[64:65], v13, s[48:51], s59 offen
K2_exit:
    s_endpgm
.p2align 8
.globl k3_out_kernel
.type k3_out_kernel,@function
k3_out_kernel:
    s_cmp_ge_u32 s2, 272
    s_cbranch_scc1 K3_exit
    s_load_dwordx16 s[16:31], s[0:1], 0
    s_load_dwordx8 s[32:39], s[0:1], 64
    v_lshlrev_b32 v1, 2, v0
    s_waitcnt lgkmcnt(0)
    s_mov_b32 s48, s38
    s_and_b32 s49, s39, 0xffff
    s_mov_b32 s50, 1073741824
    s_mov_b32 s51, 0x00020000
    s_cmp_ge_u32 s2, 128
    s_cbranch_scc1 K3_down
    s_mov_b32 s40, s24
    s_and_b32 s41, s25, 0xffff
    s_mov_b32 s42, 4718592
    s_mov_b32 s43, 0x00020000
    s_lshl_b32 s46, s2, 5
    s_mul_i32 s47, s46, 1152
    v_cmp_gt_u32 vcc, 288, v0
    s_and_saveexec_b64 s[44:45], vcc
    s_cbranch_execz K3_wo_noload
    buffer_load_dword v32, v1, s[40:43], s47 offen
    s_add_u32 s47, s47, 1152
    buffer_load_dword v33, v1, s[40:43], s47 offen
    s_add_u32 s47, s47, 1152
    buffer_load_dword v34, v1, s[40:43], s47 offen
    s_add_u32 s47, s47, 1152
    buffer_load_dword v35, v1, s[40:43], s47 offen
    s_add_u32 s47, s47, 1152
    buffer_load_dword v36, v1, s[40:43], s47 offen
    s_add_u32 s47, s47, 1152
    buffer_load_dword v37, v1, s[40:43], s47 offen
    s_add_u32 s47, s47, 1152
    buffer_load_dword v38, v1, s[40:43], s47 offen
    s_add_u32 s47, s47, 1152
    buffer_load_dword v39, v1, s[40:43], s47 offen
    s_add_u32 s47, s47, 1152
    buffer_load_dword v40, v1, s[40:43], s47 offen
    s_add_u32 s47, s47, 1152
    buffer_load_dword v41, v1, s[40:43], s47 offen
    s_add_u32 s47, s47, 1152
    buffer_load_dword v42, v1, s[40:43], s47 offen
    s_add_u32 s47, s47, 1152
    buffer_load_dword v43, v1, s[40:43], s47 offen
    s_add_u32 s47, s47, 1152
    buffer_load_dword v44, v1, s[40:43], s47 offen
    s_add_u32 s47, s47, 1152
    buffer_load_dword v45, v1, s[40:43], s47 offen
    s_add_u32 s47, s47, 1152
    buffer_load_dword v46, v1, s[40:43], s47 offen
    s_add_u32 s47, s47, 1152
    buffer_load_dword v47, v1, s[40:43], s47 offen
    s_add_u32 s47, s47, 1152
    buffer_load_dword v48, v1, s[40:43], s47 offen
    s_add_u32 s47, s47, 1152
    buffer_load_dword v49, v1, s[40:43], s47 offen
    s_add_u32 s47, s47, 1152
    buffer_load_dword v50, v1, s[40:43], s47 offen
    s_add_u32 s47, s47, 1152
    buffer_load_dword v51, v1, s[40:43], s47 offen
    s_add_u32 s47, s47, 1152
    buffer_load_dword v52, v1, s[40:43], s47 offen
    s_add_u32 s47, s47, 1152
    buffer_load_dword v53, v1, s[40:43], s47 offen
    s_add_u32 s47, s47, 1152
    buffer_load_dword v54, v1, s[40:43], s47 offen
    s_add_u32 s47, s47, 1152
    buffer_load_dword v55, v1, s[40:43], s47 offen
    s_add_u32 s47, s47, 1152
    buffer_load_dword v56, v1, s[40:43], s47 offen
    s_add_u32 s47, s47, 1152
    buffer_load_dword v57, v1, s[40:43], s47 offen
    s_add_u32 s47, s47, 1152
    buffer_load_dword v58, v1, s[40:43], s47 offen
    s_add_u32 s47, s47, 1152
    buffer_load_dword v59, v1, s[40:43], s47 offen
    s_add_u32 s47, s47, 1152
    buffer_load_dword v60, v1, s[40:43], s47 offen
    s_add_u32 s47, s47, 1152
    buffer_load_dword v61, v1, s[40:43], s47 offen
    s_add_u32 s47, s47, 1152
    buffer_load_dword v62, v1, s[40:43], s47 offen
    s_add_u32 s47, s47, 1152
    buffer_load_dword v63, v1, s[40:43], s47 offen
K3_wo_noload:
    s_mov_b64 exec, s[44:45]
    s_lshr_b32 s57, s2, 2
    s_lshl_b32 s58, s57, 9
    s_add_u32 s58, s58, 32768
    v_and_b32 v2, 63, v0
    v_lshlrev_b32 v3, 3, v2
    buffer_load_dwordx2 v[4:5], v3, s[48:51], s58 offen
    s_and_b32 s59, s2, 3
    s_lshl_b32 s60, s57, 15
    s_lshl_b32 s61, s59, 7
    s_add_u32 s60, s60, s61
    s_add_u32 s60, s60, 65536
    v_and_b32 v6, 31, v0
    v_lshlrev_b32 v6, 2, v6
    v_lshrrev_b32 v7, 5, v0
    v_lshlrev_b32 v8, 12, v7
    v_add_u32 v6, v6, v8
    v_cmp_gt_u32 vcc, 256, v0
    s_and_saveexec_b64 s[44:45], vcc
    s_cbranch_execz K3_sa_noload
    buffer_load_dword v64, v6, s[48:51], s60 offen offset:0
    buffer_load_dword v65, v6, s[48:51], s60 offen offset:512
    buffer_load_dword v66, v6, s[48:51], s60 offen offset:1024
    buffer_load_dword v67, v6, s[48:51], s60 offen offset:1536
    buffer_load_dword v68, v6, s[48:51], s60 offen offset:2048
    buffer_load_dword v69, v6, s[48:51], s60 offen offset:2560
    buffer_load_dword v70, v6, s[48:51], s60 offen offset:3072
    buffer_load_dword v71, v6, s[48:51], s60 offen offset:3584
K3_sa_noload:
    s_mov_b64 exec, s[44:45]
    s_waitcnt vmcnt(8)
    s_waitcnt vmcnt(0)
    v_mov_b32 v9, v4
    s_nop 1
    v_max_f32_dpp v9, v9, v9 row_ror:8 row_mask:0xf bank_mask:0xf
    s_nop 1
    v_max_f32_dpp v9, v9, v9 row_ror:4 row_mask:0xf bank_mask:0xf
    s_nop 1
    v_max_f32_dpp v9, v9, v9 row_ror:2 row_mask:0xf bank_mask:0xf
    s_nop 1
    v_max_f32_dpp v9, v9, v9 row_ror:1 row_mask:0xf bank_mask:0xf
    s_nop 1
    s_nop 1
    v_readlane_b32 s62, v9, 0
    v_readlane_b32 s63, v9, 16
    v_readlane_b32 s64, v9, 32
    v_readlane_b32 s65, v9, 48
    s_nop 2
    v_mov_b32 v9, s62
    v_max_f32 v9, s63, v9
    v_max_f32 v9, s64, v9
    v_max_f32 v9, s65, v9
    v_sub_f32 v10, v4, v9
    v_mul_f32 v10, 0x3e0293ee, v10
    v_exp_f32 v10, v10
    s_nop 1
    v_mul_f32 v11, v10, v5
    s_nop 1
    v_add_f32_dpp v11, v11, v11 row_ror:8 row_mask:0xf bank_mask:0xf
    s_nop 1
    v_add_f32_dpp v11, v11, v11 row_ror:4 row_mask:0xf bank_mask:0xf
    s_nop 1
    v_add_f32_dpp v11, v11, v11 row_ror:2 row_mask:0xf bank_mask:0xf
    s_nop 1
    v_add_f32_dpp v11, v11, v11 row_ror:1 row_mask:0xf bank_mask:0xf
    s_nop 1
    s_nop 1
    v_readlane_b32 s62, v11, 0
    v_readlane_b32 s63, v11, 16
    v_readlane_b32 s64, v11, 32
    v_readlane_b32 s65, v11, 48
    s_nop 2
    v_mov_b32 v11, s62
    v_add_f32 v11, s63, v11
    v_add_f32 v11, s64, v11
    v_add_f32 v11, s65, v11
    v_rcp_f32 v12, v11
    s_nop 1
    v_mul_f32 v13, v10, v12
    v_fma_f32 v14, -v11, v13, v10
    v_fma_f32 v13, v14, v12, v13
    v_lshlrev_b32 v14, 2, v2
    ds_write_b32 v14, v13
    s_waitcnt lgkmcnt(0)
    s_barrier
    v_lshlrev_b32 v14, 5, v7
    ds_read_b128 v[72:75], v14
    ds_read_b128 v[76:79], v14 offset:16
    s_waitcnt lgkmcnt(0)
    v_mul_f32 v15, v64, v72
    v_fmac_f32 v15, v65, v73
    v_fmac_f32 v15, v66, v74
    v_fmac_f32 v15, v67, v75
    v_fmac_f32 v15, v68, v76
    v_fmac_f32 v15, v69, v77
    v_fmac_f32 v15, v70, v78
    v_fmac_f32 v15, v71, v79
    v_and_b32 v16, 31, v0
    v_lshlrev_b32 v16, 2, v16
    v_lshlrev_b32 v17, 7, v7
    v_add_u32 v17, v17, v16
    ds_write_b32 v17, v15 offset:256
    s_waitcnt lgkmcnt(0)
    s_barrier
    ds_read_b32 v64, v16 offset:256
    ds_read_b32 v65, v16 offset:384
    ds_read_b32 v66, v16 offset:512
    ds_read_b32 v67, v16 offset:640
    ds_read_b32 v68, v16 offset:768
    ds_read_b32 v69, v16 offset:896
    ds_read_b32 v70, v16 offset:1024
    ds_read_b32 v71, v16 offset:1152
    s_waitcnt lgkmcnt(0)
    v_add_f32 v64, v64, v65
    v_add_f32 v64, v64, v66
    v_add_f32 v64, v64, v67
    v_add_f32 v64, v64, v68
    v_add_f32 v64, v64, v69
    v_add_f32 v64, v64, v70
    v_add_f32 v64, v64, v71
    v_cvt_pk_bf16_f32 v64, v64, v64
    v_and_b32 v64, 0xffff0000, v64
    s_barrier
    ds_write_b32 v16, v64 offset:2048
    s_waitcnt lgkmcnt(0)
    s_barrier
    v_mov_b32 v16, 0
    ds_read_b128 v[64:67], v16 offset:2048
    ds_read_b128 v[68:71], v16 offset:2064
    ds_read_b128 v[72:75], v16 offset:2080
    ds_read_b128 v[76:79], v16 offset:2096
    ds_read_b128 v[80:83], v16 offset:2112
    ds_read_b128 v[84:87], v16 offset:2128
    ds_read_b128 v[88:91], v16 offset:2144
    ds_read_b128 v[92:95], v16 offset:2160
    s_waitcnt lgkmcnt(0)
    v_mov_b32 v20, 0
    v_mov_b32 v21, 0
    v_lshlrev_b32 v22, 16, v32
    v_and_b32 v23, 0xffff0000, v32
    v_fmac_f32 v20, v22, v64
    v_fmac_f32 v21, v23, v64
    v_lshlrev_b32 v22, 16, v33
    v_and_b32 v23, 0xffff0000, v33
    v_fmac_f32 v20, v22, v65
    v_fmac_f32 v21, v23, v65
    v_lshlrev_b32 v22, 16, v34
    v_and_b32 v23, 0xffff0000, v34
    v_fmac_f32 v20, v22, v66
    v_fmac_f32 v21, v23, v66
    v_lshlrev_b32 v22, 16, v35
    v_and_b32 v23, 0xffff0000, v35
    v_fmac_f32 v20, v22, v67
    v_fmac_f32 v21, v23, v67
    v_lshlrev_b32 v22, 16, v36
    v_and_b32 v23, 0xffff0000, v36
    v_fmac_f32 v20, v22, v68
    v_fmac_f32 v21, v23, v68
    v_lshlrev_b32 v22, 16, v37
    v_and_b32 v23, 0xffff0000, v37
    v_fmac_f32 v20, v22, v69
    v_fmac_f32 v21, v23, v69
    v_lshlrev_b32 v22, 16, v38
    v_and_b32 v23, 0xffff0000, v38
    v_fmac_f32 v20, v22, v70
    v_fmac_f32 v21, v23, v70
    v_lshlrev_b32 v22, 16, v39
    v_and_b32 v23, 0xffff0000, v39
    v_fmac_f32 v20, v22, v71
    v_fmac_f32 v21, v23, v71
    v_lshlrev_b32 v22, 16, v40
    v_and_b32 v23, 0xffff0000, v40
    v_fmac_f32 v20, v22, v72
    v_fmac_f32 v21, v23, v72
    v_lshlrev_b32 v22, 16, v41
    v_and_b32 v23, 0xffff0000, v41
    v_fmac_f32 v20, v22, v73
    v_fmac_f32 v21, v23, v73
    v_lshlrev_b32 v22, 16, v42
    v_and_b32 v23, 0xffff0000, v42
    v_fmac_f32 v20, v22, v74
    v_fmac_f32 v21, v23, v74
    v_lshlrev_b32 v22, 16, v43
    v_and_b32 v23, 0xffff0000, v43
    v_fmac_f32 v20, v22, v75
    v_fmac_f32 v21, v23, v75
    v_lshlrev_b32 v22, 16, v44
    v_and_b32 v23, 0xffff0000, v44
    v_fmac_f32 v20, v22, v76
    v_fmac_f32 v21, v23, v76
    v_lshlrev_b32 v22, 16, v45
    v_and_b32 v23, 0xffff0000, v45
    v_fmac_f32 v20, v22, v77
    v_fmac_f32 v21, v23, v77
    v_lshlrev_b32 v22, 16, v46
    v_and_b32 v23, 0xffff0000, v46
    v_fmac_f32 v20, v22, v78
    v_fmac_f32 v21, v23, v78
    v_lshlrev_b32 v22, 16, v47
    v_and_b32 v23, 0xffff0000, v47
    v_fmac_f32 v20, v22, v79
    v_fmac_f32 v21, v23, v79
    v_lshlrev_b32 v22, 16, v48
    v_and_b32 v23, 0xffff0000, v48
    v_fmac_f32 v20, v22, v80
    v_fmac_f32 v21, v23, v80
    v_lshlrev_b32 v22, 16, v49
    v_and_b32 v23, 0xffff0000, v49
    v_fmac_f32 v20, v22, v81
    v_fmac_f32 v21, v23, v81
    v_lshlrev_b32 v22, 16, v50
    v_and_b32 v23, 0xffff0000, v50
    v_fmac_f32 v20, v22, v82
    v_fmac_f32 v21, v23, v82
    v_lshlrev_b32 v22, 16, v51
    v_and_b32 v23, 0xffff0000, v51
    v_fmac_f32 v20, v22, v83
    v_fmac_f32 v21, v23, v83
    v_lshlrev_b32 v22, 16, v52
    v_and_b32 v23, 0xffff0000, v52
    v_fmac_f32 v20, v22, v84
    v_fmac_f32 v21, v23, v84
    v_lshlrev_b32 v22, 16, v53
    v_and_b32 v23, 0xffff0000, v53
    v_fmac_f32 v20, v22, v85
    v_fmac_f32 v21, v23, v85
    v_lshlrev_b32 v22, 16, v54
    v_and_b32 v23, 0xffff0000, v54
    v_fmac_f32 v20, v22, v86
    v_fmac_f32 v21, v23, v86
    v_lshlrev_b32 v22, 16, v55
    v_and_b32 v23, 0xffff0000, v55
    v_fmac_f32 v20, v22, v87
    v_fmac_f32 v21, v23, v87
    v_lshlrev_b32 v22, 16, v56
    v_and_b32 v23, 0xffff0000, v56
    v_fmac_f32 v20, v22, v88
    v_fmac_f32 v21, v23, v88
    v_lshlrev_b32 v22, 16, v57
    v_and_b32 v23, 0xffff0000, v57
    v_fmac_f32 v20, v22, v89
    v_fmac_f32 v21, v23, v89
    v_lshlrev_b32 v22, 16, v58
    v_and_b32 v23, 0xffff0000, v58
    v_fmac_f32 v20, v22, v90
    v_fmac_f32 v21, v23, v90
    v_lshlrev_b32 v22, 16, v59
    v_and_b32 v23, 0xffff0000, v59
    v_fmac_f32 v20, v22, v91
    v_fmac_f32 v21, v23, v91
    v_lshlrev_b32 v22, 16, v60
    v_and_b32 v23, 0xffff0000, v60
    v_fmac_f32 v20, v22, v92
    v_fmac_f32 v21, v23, v92
    v_lshlrev_b32 v22, 16, v61
    v_and_b32 v23, 0xffff0000, v61
    v_fmac_f32 v20, v22, v93
    v_fmac_f32 v21, v23, v93
    v_lshlrev_b32 v22, 16, v62
    v_and_b32 v23, 0xffff0000, v62
    v_fmac_f32 v20, v22, v94
    v_fmac_f32 v21, v23, v94
    v_lshlrev_b32 v22, 16, v63
    v_and_b32 v23, 0xffff0000, v63
    v_fmac_f32 v20, v22, v95
    v_fmac_f32 v21, v23, v95
    s_mul_i32 s46, s2, 2304
    s_add_u32 s46, s46, 2097152
    v_lshlrev_b32 v22, 3, v0
    v_cmp_gt_u32 vcc, 288, v0
    s_and_saveexec_b64 s[44:45], vcc
    s_cbranch_execz K3_exit
    buffer_store_dwordx2 v[20:21], v22, s[48:51], s46 offen
    s_branch K3_exit
K3_down:
    s_mov_b32 s40, s32
    s_and_b32 s41, s33, 0xffff
    s_mov_b32 s42, 5308416
    s_mov_b32 s43, 0x00020000
    s_sub_u32 s57, s2, 128
    s_lshl_b32 s46, s57, 5
    s_mul_i32 s47, s46, 1152
    s_lshl_b32 s58, s46, 2
    s_add_u32 s58, s58, 8192
    s_add_u32 s62, s38, s58
    s_addc_u32 s63, s39, 0
    s_load_dwordx16 s[64:79], s[62:63], 0
    s_load_dwordx16 s[80:95], s[62:63], 64
    v_cmp_gt_u32 vcc, 288, v0
    s_and_saveexec_b64 s[44:45], vcc
    s_cbranch_execz K3_exit
    buffer_load_dword v32, v1, s[40:43], s47 offen
    s_add_u32 s47, s47, 1152
    buffer_load_dword v33, v1, s[40:43], s47 offen
    s_add_u32 s47, s47, 1152
    buffer_load_dword v34, v1, s[40:43], s47 offen
    s_add_u32 s47, s47, 1152
    buffer_load_dword v35, v1, s[40:43], s47 offen
    s_add_u32 s47, s47, 1152
    buffer_load_dword v36, v1, s[40:43], s47 offen
    s_add_u32 s47, s47, 1152
    buffer_load_dword v37, v1, s[40:43], s47 offen
    s_add_u32 s47, s47, 1152
    buffer_load_dword v38, v1, s[40:43], s47 offen
    s_add_u32 s47, s47, 1152
    buffer_load_dword v39, v1, s[40:43], s47 offen
    s_add_u32 s47, s47, 1152
    buffer_load_dword v40, v1, s[40:43], s47 offen
    s_add_u32 s47, s47, 1152
    buffer_load_dword v41, v1, s[40:43], s47 offen
    s_add_u32 s47, s47, 1152
    buffer_load_dword v42, v1, s[40:43], s47 offen
    s_add_u32 s47, s47, 1152
    buffer_load_dword v43, v1, s[40:43], s47 offen
    s_add_u32 s47, s47, 1152
    buffer_load_dword v44, v1, s[40:43], s47 offen
    s_add_u32 s47, s47, 1152
    buffer_load_dword v45, v1, s[40:43], s47 offen
    s_add_u32 s47, s47, 1152
    buffer_load_dword v46, v1, s[40:43], s47 offen
    s_add_u32 s47, s47, 1152
    buffer_load_dword v47, v1, s[40:43], s47 offen
    s_add_u32 s47, s47, 1152
    buffer_load_dword v48, v1, s[40:43], s47 offen
    s_add_u32 s47, s47, 1152
    buffer_load_dword v49, v1, s[40:43], s47 offen
    s_add_u32 s47, s47, 1152
    buffer_load_dword v50, v1, s[40:43], s47 offen
    s_add_u32 s47, s47, 1152
    buffer_load_dword v51, v1, s[40:43], s47 offen
    s_add_u32 s47, s47, 1152
    buffer_load_dword v52, v1, s[40:43], s47 offen
    s_add_u32 s47, s47, 1152
    buffer_load_dword v53, v1, s[40:43], s47 offen
    s_add_u32 s47, s47, 1152
    buffer_load_dword v54, v1, s[40:43], s47 offen
    s_add_u32 s47, s47, 1152
    buffer_load_dword v55, v1, s[40:43], s47 offen
    s_add_u32 s47, s47, 1152
    buffer_load_dword v56, v1, s[40:43], s47 offen
    s_add_u32 s47, s47, 1152
    buffer_load_dword v57, v1, s[40:43], s47 offen
    s_add_u32 s47, s47, 1152
    buffer_load_dword v58, v1, s[40:43], s47 offen
    s_add_u32 s47, s47, 1152
    buffer_load_dword v59, v1, s[40:43], s47 offen
    s_add_u32 s47, s47, 1152
    buffer_load_dword v60, v1, s[40:43], s47 offen
    s_add_u32 s47, s47, 1152
    buffer_load_dword v61, v1, s[40:43], s47 offen
    s_add_u32 s47, s47, 1152
    buffer_load_dword v62, v1, s[40:43], s47 offen
    s_add_u32 s47, s47, 1152
    buffer_load_dword v63, v1, s[40:43], s47 offen
    v_mov_b32 v20, 0
    v_mov_b32 v21, 0
    s_waitcnt vmcnt(0) lgkmcnt(0)
    v_lshlrev_b32 v22, 16, v32
    v_and_b32 v23, 0xffff0000, v32
    v_fmac_f32 v20, s64, v22
    v_fmac_f32 v21, s64, v23
    v_lshlrev_b32 v22, 16, v33
    v_and_b32 v23, 0xffff0000, v33
    v_fmac_f32 v20, s65, v22
    v_fmac_f32 v21, s65, v23
    v_lshlrev_b32 v22, 16, v34
    v_and_b32 v23, 0xffff0000, v34
    v_fmac_f32 v20, s66, v22
    v_fmac_f32 v21, s66, v23
    v_lshlrev_b32 v22, 16, v35
    v_and_b32 v23, 0xffff0000, v35
    v_fmac_f32 v20, s67, v22
    v_fmac_f32 v21, s67, v23
    v_lshlrev_b32 v22, 16, v36
    v_and_b32 v23, 0xffff0000, v36
    v_fmac_f32 v20, s68, v22
    v_fmac_f32 v21, s68, v23
    v_lshlrev_b32 v22, 16, v37
    v_and_b32 v23, 0xffff0000, v37
    v_fmac_f32 v20, s69, v22
    v_fmac_f32 v21, s69, v23
    v_lshlrev_b32 v22, 16, v38
    v_and_b32 v23, 0xffff0000, v38
    v_fmac_f32 v20, s70, v22
    v_fmac_f32 v21, s70, v23
    v_lshlrev_b32 v22, 16, v39
    v_and_b32 v23, 0xffff0000, v39
    v_fmac_f32 v20, s71, v22
    v_fmac_f32 v21, s71, v23
    v_lshlrev_b32 v22, 16, v40
    v_and_b32 v23, 0xffff0000, v40
    v_fmac_f32 v20, s72, v22
    v_fmac_f32 v21, s72, v23
    v_lshlrev_b32 v22, 16, v41
    v_and_b32 v23, 0xffff0000, v41
    v_fmac_f32 v20, s73, v22
    v_fmac_f32 v21, s73, v23
    v_lshlrev_b32 v22, 16, v42
    v_and_b32 v23, 0xffff0000, v42
    v_fmac_f32 v20, s74, v22
    v_fmac_f32 v21, s74, v23
    v_lshlrev_b32 v22, 16, v43
    v_and_b32 v23, 0xffff0000, v43
    v_fmac_f32 v20, s75, v22
    v_fmac_f32 v21, s75, v23
    v_lshlrev_b32 v22, 16, v44
    v_and_b32 v23, 0xffff0000, v44
    v_fmac_f32 v20, s76, v22
    v_fmac_f32 v21, s76, v23
    v_lshlrev_b32 v22, 16, v45
    v_and_b32 v23, 0xffff0000, v45
    v_fmac_f32 v20, s77, v22
    v_fmac_f32 v21, s77, v23
    v_lshlrev_b32 v22, 16, v46
    v_and_b32 v23, 0xffff0000, v46
    v_fmac_f32 v20, s78, v22
    v_fmac_f32 v21, s78, v23
    v_lshlrev_b32 v22, 16, v47
    v_and_b32 v23, 0xffff0000, v47
    v_fmac_f32 v20, s79, v22
    v_fmac_f32 v21, s79, v23
    v_lshlrev_b32 v22, 16, v48
    v_and_b32 v23, 0xffff0000, v48
    v_fmac_f32 v20, s80, v22
    v_fmac_f32 v21, s80, v23
    v_lshlrev_b32 v22, 16, v49
    v_and_b32 v23, 0xffff0000, v49
    v_fmac_f32 v20, s81, v22
    v_fmac_f32 v21, s81, v23
    v_lshlrev_b32 v22, 16, v50
    v_and_b32 v23, 0xffff0000, v50
    v_fmac_f32 v20, s82, v22
    v_fmac_f32 v21, s82, v23
    v_lshlrev_b32 v22, 16, v51
    v_and_b32 v23, 0xffff0000, v51
    v_fmac_f32 v20, s83, v22
    v_fmac_f32 v21, s83, v23
    v_lshlrev_b32 v22, 16, v52
    v_and_b32 v23, 0xffff0000, v52
    v_fmac_f32 v20, s84, v22
    v_fmac_f32 v21, s84, v23
    v_lshlrev_b32 v22, 16, v53
    v_and_b32 v23, 0xffff0000, v53
    v_fmac_f32 v20, s85, v22
    v_fmac_f32 v21, s85, v23
    v_lshlrev_b32 v22, 16, v54
    v_and_b32 v23, 0xffff0000, v54
    v_fmac_f32 v20, s86, v22
    v_fmac_f32 v21, s86, v23
    v_lshlrev_b32 v22, 16, v55
    v_and_b32 v23, 0xffff0000, v55
    v_fmac_f32 v20, s87, v22
    v_fmac_f32 v21, s87, v23
    v_lshlrev_b32 v22, 16, v56
    v_and_b32 v23, 0xffff0000, v56
    v_fmac_f32 v20, s88, v22
    v_fmac_f32 v21, s88, v23
    v_lshlrev_b32 v22, 16, v57
    v_and_b32 v23, 0xffff0000, v57
    v_fmac_f32 v20, s89, v22
    v_fmac_f32 v21, s89, v23
    v_lshlrev_b32 v22, 16, v58
    v_and_b32 v23, 0xffff0000, v58
    v_fmac_f32 v20, s90, v22
    v_fmac_f32 v21, s90, v23
    v_lshlrev_b32 v22, 16, v59
    v_and_b32 v23, 0xffff0000, v59
    v_fmac_f32 v20, s91, v22
    v_fmac_f32 v21, s91, v23
    v_lshlrev_b32 v22, 16, v60
    v_and_b32 v23, 0xffff0000, v60
    v_fmac_f32 v20, s92, v22
    v_fmac_f32 v21, s92, v23
    v_lshlrev_b32 v22, 16, v61
    v_and_b32 v23, 0xffff0000, v61
    v_fmac_f32 v20, s93, v22
    v_fmac_f32 v21, s93, v23
    v_lshlrev_b32 v22, 16, v62
    v_and_b32 v23, 0xffff0000, v62
    v_fmac_f32 v20, s94, v22
    v_fmac_f32 v21, s94, v23
    v_lshlrev_b32 v22, 16, v63
    v_and_b32 v23, 0xffff0000, v63
    v_fmac_f32 v20, s95, v22
    v_fmac_f32 v21, s95, v23
    s_mul_i32 s46, s57, 2304
    s_add_u32 s46, s46, 3145728
    v_lshlrev_b32 v22, 3, v0
    buffer_store_dwordx2 v[20:21], v22, s[48:51], s46 offen
K3_exit:
    s_endpgm
.p2align 8
.globl k4_final_kernel
.type k4_final_kernel,@function
k4_final_kernel:
    s_cmp_ge_u32 s2, 9
    s_cbranch_scc1 K4_exit
    s_load_dwordx16 s[16:31], s[0:1], 0
    s_load_dwordx8 s[32:39], s[0:1], 64
    v_and_b32 v1, 63, v0
    v_lshlrev_b32 v1, 2, v1
    s_lshl_b32 s46, s2, 8
    v_add_u32 v1, s46, v1
    v_lshrrev_b32 v2, 6, v0
    s_mov_b32 s47, 2304
    v_mul_lo_u32 v3, v2, s47
    v_lshlrev_b32 v4, 5, v3
    v_add_u32 v4, v4, v1
    v_mul_u32_u24 v5, 36, v3
    v_add_u32 v5, v5, v1
    s_waitcnt lgkmcnt(0)
    s_mov_b32 s48, s38
    s_and_b32 s49, s39, 0xffff
    s_mov_b32 s50, 1073741824
    s_mov_b32 s51, 0x00020000
    s_mov_b32 s40, s16
    s_and_b32 s41, s17, 0xffff
    s_mov_b32 s42, 1152
    s_mov_b32 s43, 0x00020000
    s_mov_b32 s52, s34
    s_and_b32 s53, s35, 0xffff
    s_mov_b32 s54, 1152
    s_mov_b32 s55, 0x00020000
    s_mov_b32 s47, 2097152
    buffer_load_dword v16, v4, s[48:51], s47 offen
    s_add_u32 s47, s47, 2304
    buffer_load_dword v17, v4, s[48:51], s47 offen
    s_add_u32 s47, s47, 2304
    buffer_load_dword v18, v4, s[48:51], s47 offen
    s_add_u32 s47, s47, 2304
    buffer_load_dword v19, v4, s[48:51], s47 offen
    s_add_u32 s47, s47, 2304
    buffer_load_dword v20, v4, s[48:51], s47 offen
    s_add_u32 s47, s47, 2304
    buffer_load_dword v21, v4, s[48:51], s47 offen
    s_add_u32 s47, s47, 2304
    buffer_load_dword v22, v4, s[48:51], s47 offen
    s_add_u32 s47, s47, 2304
    buffer_load_dword v23, v4, s[48:51], s47 offen
    s_add_u32 s47, s47, 2304
    buffer_load_dword v24, v4, s[48:51], s47 offen
    s_add_u32 s47, s47, 2304
    buffer_load_dword v25, v4, s[48:51], s47 offen
    s_add_u32 s47, s47, 2304
    buffer_load_dword v26, v4, s[48:51], s47 offen
    s_add_u32 s47, s47, 2304
    buffer_load_dword v27, v4, s[48:51], s47 offen
    s_add_u32 s47, s47, 2304
    buffer_load_dword v28, v4, s[48:51], s47 offen
    s_add_u32 s47, s47, 2304
    buffer_load_dword v29, v4, s[48:51], s47 offen
    s_add_u32 s47, s47, 2304
    buffer_load_dword v30, v4, s[48:51], s47 offen
    s_add_u32 s47, s47, 2304
    buffer_load_dword v31, v4, s[48:51], s47 offen
    s_add_u32 s47, s47, 2304
    buffer_load_dword v32, v4, s[48:51], s47 offen
    s_add_u32 s47, s47, 2304
    buffer_load_dword v33, v4, s[48:51], s47 offen
    s_add_u32 s47, s47, 2304
    buffer_load_dword v34, v4, s[48:51], s47 offen
    s_add_u32 s47, s47, 2304
    buffer_load_dword v35, v4, s[48:51], s47 offen
    s_add_u32 s47, s47, 2304
    buffer_load_dword v36, v4, s[48:51], s47 offen
    s_add_u32 s47, s47, 2304
    buffer_load_dword v37, v4, s[48:51], s47 offen
    s_add_u32 s47, s47, 2304
    buffer_load_dword v38, v4, s[48:51], s47 offen
    s_add_u32 s47, s47, 2304
    buffer_load_dword v39, v4, s[48:51], s47 offen
    s_add_u32 s47, s47, 2304
    buffer_load_dword v40, v4, s[48:51], s47 offen
    s_add_u32 s47, s47, 2304
    buffer_load_dword v41, v4, s[48:51], s47 offen
    s_add_u32 s47, s47, 2304
    buffer_load_dword v42, v4, s[48:51], s47 offen
    s_add_u32 s47, s47, 2304
    buffer_load_dword v43, v4, s[48:51], s47 offen
    s_add_u32 s47, s47, 2304
    buffer_load_dword v44, v4, s[48:51], s47 offen
    s_add_u32 s47, s47, 2304
    buffer_load_dword v45, v4, s[48:51], s47 offen
    s_add_u32 s47, s47, 2304
    buffer_load_dword v46, v4, s[48:51], s47 offen
    s_add_u32 s47, s47, 2304
    buffer_load_dword v47, v4, s[48:51], s47 offen
    s_mov_b32 s47, 3145728
    buffer_load_dword v48, v5, s[48:51], s47 offen
    s_add_u32 s47, s47, 2304
    buffer_load_dword v49, v5, s[48:51], s47 offen
    s_add_u32 s47, s47, 2304
    buffer_load_dword v50, v5, s[48:51], s47 offen
    s_add_u32 s47, s47, 2304
    buffer_load_dword v51, v5, s[48:51], s47 offen
    s_add_u32 s47, s47, 2304
    buffer_load_dword v52, v5, s[48:51], s47 offen
    s_add_u32 s47, s47, 2304
    buffer_load_dword v53, v5, s[48:51], s47 offen
    s_add_u32 s47, s47, 2304
    buffer_load_dword v54, v5, s[48:51], s47 offen
    s_add_u32 s47, s47, 2304
    buffer_load_dword v55, v5, s[48:51], s47 offen
    s_add_u32 s47, s47, 2304
    buffer_load_dword v56, v5, s[48:51], s47 offen
    s_add_u32 s47, s47, 2304
    buffer_load_dword v57, v5, s[48:51], s47 offen
    s_add_u32 s47, s47, 2304
    buffer_load_dword v58, v5, s[48:51], s47 offen
    s_add_u32 s47, s47, 2304
    buffer_load_dword v59, v5, s[48:51], s47 offen
    s_add_u32 s47, s47, 2304
    buffer_load_dword v60, v5, s[48:51], s47 offen
    s_add_u32 s47, s47, 2304
    buffer_load_dword v61, v5, s[48:51], s47 offen
    s_add_u32 s47, s47, 2304
    buffer_load_dword v62, v5, s[48:51], s47 offen
    s_add_u32 s47, s47, 2304
    buffer_load_dword v63, v5, s[48:51], s47 offen
    s_add_u32 s47, s47, 2304
    buffer_load_dword v64, v5, s[48:51], s47 offen
    s_add_u32 s47, s47, 2304
    buffer_load_dword v65, v5, s[48:51], s47 offen
    s_add_u32 s47, s47, 2304
    buffer_load_dword v66, v5, s[48:51], s47 offen
    s_add_u32 s47, s47, 2304
    buffer_load_dword v67, v5, s[48:51], s47 offen
    s_add_u32 s47, s47, 2304
    buffer_load_dword v68, v5, s[48:51], s47 offen
    s_add_u32 s47, s47, 2304
    buffer_load_dword v69, v5, s[48:51], s47 offen
    s_add_u32 s47, s47, 2304
    buffer_load_dword v70, v5, s[48:51], s47 offen
    s_add_u32 s47, s47, 2304
    buffer_load_dword v71, v5, s[48:51], s47 offen
    s_add_u32 s47, s47, 2304
    buffer_load_dword v72, v5, s[48:51], s47 offen
    s_add_u32 s47, s47, 2304
    buffer_load_dword v73, v5, s[48:51], s47 offen
    s_add_u32 s47, s47, 2304
    buffer_load_dword v74, v5, s[48:51], s47 offen
    s_add_u32 s47, s47, 2304
    buffer_load_dword v75, v5, s[48:51], s47 offen
    s_add_u32 s47, s47, 2304
    buffer_load_dword v76, v5, s[48:51], s47 offen
    s_add_u32 s47, s47, 2304
    buffer_load_dword v77, v5, s[48:51], s47 offen
    s_add_u32 s47, s47, 2304
    buffer_load_dword v78, v5, s[48:51], s47 offen
    s_add_u32 s47, s47, 2304
    buffer_load_dword v79, v5, s[48:51], s47 offen
    s_add_u32 s47, s47, 2304
    buffer_load_dword v80, v5, s[48:51], s47 offen
    s_add_u32 s47, s47, 2304
    buffer_load_dword v81, v5, s[48:51], s47 offen
    s_add_u32 s47, s47, 2304
    buffer_load_dword v82, v5, s[48:51], s47 offen
    s_add_u32 s47, s47, 2304
    buffer_load_dword v83, v5, s[48:51], s47 offen
    v_lshrrev_b32 v6, 1, v1
    buffer_load_ushort v7, v6, s[40:43], 0 offen
    s_waitcnt vmcnt(1)
    v_add_f32 v16, v16, v17
    v_add_f32 v18, v18, v19
    v_add_f32 v20, v20, v21
    v_add_f32 v22, v22, v23
    v_add_f32 v24, v24, v25
    v_add_f32 v26, v26, v27
    v_add_f32 v28, v28, v29
    v_add_f32 v30, v30, v31
    v_add_f32 v16, v16, v18
    v_add_f32 v20, v20, v22
    v_add_f32 v24, v24, v26
    v_add_f32 v28, v28, v30
    v_add_f32 v16, v16, v20
    v_add_f32 v24, v24, v28
    v_add_f32 v16, v16, v24
    v_add_f32 v32, v32, v33
    v_add_f32 v34, v34, v35
    v_add_f32 v36, v36, v37
    v_add_f32 v38, v38, v39
    v_add_f32 v40, v40, v41
    v_add_f32 v42, v42, v43
    v_add_f32 v44, v44, v45
    v_add_f32 v46, v46, v47
    v_add_f32 v32, v32, v34
    v_add_f32 v36, v36, v38
    v_add_f32 v40, v40, v42
    v_add_f32 v44, v44, v46
    v_add_f32 v32, v32, v36
    v_add_f32 v40, v40, v44
    v_add_f32 v32, v32, v40
    v_add_f32 v16, v16, v32
    v_add_f32 v48, v48, v49
    v_add_f32 v50, v50, v51
    v_add_f32 v52, v52, v53
    v_add_f32 v54, v54, v55
    v_add_f32 v56, v56, v57
    v_add_f32 v58, v58, v59
    v_add_f32 v60, v60, v61
    v_add_f32 v62, v62, v63
    v_add_f32 v48, v48, v50
    v_add_f32 v52, v52, v54
    v_add_f32 v56, v56, v58
    v_add_f32 v60, v60, v62
    v_add_f32 v48, v48, v52
    v_add_f32 v56, v56, v60
    v_add_f32 v48, v48, v56
    v_add_f32 v64, v64, v65
    v_add_f32 v66, v66, v67
    v_add_f32 v68, v68, v69
    v_add_f32 v70, v70, v71
    v_add_f32 v72, v72, v73
    v_add_f32 v74, v74, v75
    v_add_f32 v76, v76, v77
    v_add_f32 v78, v78, v79
    v_add_f32 v64, v64, v66
    v_add_f32 v68, v68, v70
    v_add_f32 v72, v72, v74
    v_add_f32 v76, v76, v78
    v_add_f32 v64, v64, v68
    v_add_f32 v72, v72, v76
    v_add_f32 v64, v64, v72
    v_add_f32 v48, v48, v64
    v_add_f32 v48, v48, v80
    v_add_f32 v48, v48, v81
    v_add_f32 v48, v48, v82
    v_add_f32 v48, v48, v83
    v_lshlrev_b32 v8, 2, v0
    ds_write_b32 v8, v16
    ds_write_b32 v8, v48 offset:1024
    s_waitcnt lgkmcnt(0)
    s_barrier
    v_and_b32 v8, 63, v0
    v_lshlrev_b32 v8, 2, v8
    ds_read_b32 v16, v8 offset:0
    ds_read_b32 v20, v8 offset:1024
    ds_read_b32 v17, v8 offset:256
    ds_read_b32 v21, v8 offset:1280
    ds_read_b32 v18, v8 offset:512
    ds_read_b32 v22, v8 offset:1536
    ds_read_b32 v19, v8 offset:768
    ds_read_b32 v23, v8 offset:1792
    s_waitcnt lgkmcnt(0) vmcnt(0)
    v_add_f32 v16, v16, v17
    v_add_f32 v18, v18, v19
    v_add_f32 v16, v16, v18
    v_add_f32 v20, v20, v21
    v_add_f32 v22, v22, v23
    v_add_f32 v20, v20, v22
    v_cvt_pk_bf16_f32 v16, v16, v16
    v_and_b32 v16, 0xffff0000, v16
    v_cvt_pk_bf16_f32 v20, v20, v20
    v_and_b32 v20, 0xffff0000, v20
    v_mul_f32 v21, 0xbfb8aa3b, v20
    v_exp_f32 v21, v21
    s_nop 1
    v_add_f32 v21, 1.0, v21
    v_rcp_f32 v22, v21
    s_nop 1
    v_mul_f32 v23, v20, v22
    v_fma_f32 v24, -v21, v23, v20
    v_fma_f32 v23, v24, v22, v23
    v_cvt_pk_bf16_f32 v23, v23, v23
    v_and_b32 v23, 0xffff0000, v23
    v_mul_f32 v23, v16, v23
    v_cvt_pk_bf16_f32 v23, v23, v23
    v_and_b32 v23, 0xffff0000, v23
    v_lshlrev_b32 v7, 16, v7
    v_add_f32 v23, v7, v23
    v_cvt_pk_bf16_f32 v23, v23, v23
    v_cmp_gt_u32 vcc, 64, v0
    s_and_saveexec_b64 s[44:45], vcc
    s_cbranch_execz K4_exit
    buffer_store_short v23, v6, s[52:55], 0 offen
K4_exit:
    s_endpgm
.section .rodata,"a"
.p2align 6
.amdhsa_kernel k1_proj_kernel
  .amdhsa_next_free_vgpr 104
  .amdhsa_next_free_sgpr 102
  .amdhsa_accum_offset 104
  .amdhsa_group_segment_fixed_size 0
  .amdhsa_kernarg_size 96
  .amdhsa_user_sgpr_count 2
  .amdhsa_user_sgpr_kernarg_segment_ptr 1
  .amdhsa_system_sgpr_workgroup_id_x 1
.end_amdhsa_kernel
.p2align 6
.amdhsa_kernel k2_attn_kernel
  .amdhsa_next_free_vgpr 128
  .amdhsa_next_free_sgpr 102
  .amdhsa_accum_offset 128
  .amdhsa_group_segment_fixed_size 0
  .amdhsa_kernarg_size 96
  .amdhsa_user_sgpr_count 2
  .amdhsa_user_sgpr_kernarg_segment_ptr 1
  .amdhsa_system_sgpr_workgroup_id_x 1
.end_amdhsa_kernel
.p2align 6
.amdhsa_kernel k3_out_kernel
  .amdhsa_next_free_vgpr 96
  .amdhsa_next_free_sgpr 102
  .amdhsa_accum_offset 96
  .amdhsa_group_segment_fixed_size 0
  .amdhsa_kernarg_size 96
  .amdhsa_user_sgpr_count 2
  .amdhsa_user_sgpr_kernarg_segment_ptr 1
  .amdhsa_system_sgpr_workgroup_id_x 1
.end_amdhsa_kernel
.p2align 6
.amdhsa_kernel k4_final_kernel
  .amdhsa_next_free_vgpr 88
  .amdhsa_next_free_sgpr 102
  .amdhsa_accum_offset 88
  .amdhsa_group_segment_fixed_size 0
  .amdhsa_kernarg_size 96
  .amdhsa_user_sgpr_count 2
  .amdhsa_user_sgpr_kernarg_segment_ptr 1
  .amdhsa_system_sgpr_workgroup_id_x 1
.end_amdhsa_kernel
```
